```python
import torch

def _softmax(x, axis=-1):
    return torch.softmax(x, dim=axis)
def _gelu(x):
    return torch.nn.functional.gelu(x, approximate="tanh")
def _silu(x):
    return torch.nn.functional.silu(x)
def _sigmoid(x):
    return torch.sigmoid(x)
def _layernorm(x, axis=-1, eps=1e-5):
    m = x.mean(dim=axis, keepdim=True)
    v = x.var(dim=axis, keepdim=True, unbiased=False)
    return (x - m) / torch.sqrt(v + eps)
def _scatter_add(tgt, idx, src, axis=0):
    return tgt.clone().index_add_(axis, idx, src)
def _segment_sum(src, seg, n):
    out = torch.zeros((n,) + src.shape[1:], dtype=src.dtype)
    return out.index_add_(0, seg, src)
def _pad(x, pw):
    flat = tuple(v for pair in reversed(pw) for v in pair)
    return torch.nn.functional.pad(x, flat)

kernel_name = 'parallel_sum__linear_kernel_hedgehog__mixer_channel_mlp__prompt'

def setup_inputs():

    _w = (lambda a: (lambda t: t.to(torch.bfloat16) if t.is_floating_point() else t)(torch.as_tensor(a)))
    def _A_setup():
        B, S, D, H = 1, 2048, 512, 32
        Dh = D // H
        return {
            "x": _w((lambda *s: torch.randn(*s, dtype=torch.bfloat16) * 0.05)(B, S, D)),
            "wqkv": _w((lambda *s: torch.randn(*s, dtype=torch.bfloat16) * 0.2)(D, 3 * D)),
            "w_phi": _w((lambda *s: torch.randn(*s, dtype=torch.bfloat16) * 0.2)(H, Dh, Dh) * (Dh ** -0.5)),
            "wo": _w((lambda *s: torch.randn(*s, dtype=torch.bfloat16) * 0.05)(D, D)),
        }
    _A_in = _A_setup()

    def _B_setup():
        B, S, D, F = 1, 2048, 512, 1376
        return {
            "x": _w((lambda *s: torch.randn(*s, dtype=torch.bfloat16) * 0.05)(B, S, D)),
            "w1": _w((lambda *s: torch.randn(*s, dtype=torch.bfloat16) * 1.6)(D, F) * (D ** -0.5)),
            "b1": _w((lambda *s: torch.randn(*s, dtype=torch.bfloat16) * 1.6)(F)),
            "w2": _w((lambda *s: torch.randn(*s, dtype=torch.bfloat16) * 0.05)(F, D) * (F ** -0.5)),
            "b2": _w((lambda *s: torch.randn(*s, dtype=torch.bfloat16) * 0.05)(D)),
        }
    _B_in = _B_setup()

    return {
        "A_x": _A_in["x"],
        "A_wqkv": _A_in["wqkv"],
        "A_w_phi": _A_in["w_phi"],
        "A_wo": _A_in["wo"],
        "B_x": _B_in["x"],
        "B_w1": _B_in["w1"],
        "B_b1": _B_in["b1"],
        "B_w2": _B_in["w2"],
        "B_b2": _B_in["b2"],
    }

def reference(A_x, A_wqkv, A_w_phi, A_wo, B_x, B_w1, B_b1, B_w2, B_b2):
    def _A_ref(x, wqkv, w_phi, wo):
        B, S, D = x.shape
        H = 32; Dh = D // H
        qkv = (lambda x, *d: x.permute(*d))((x @ wqkv).reshape(B, S, 3, H, Dh), 2, 0, 3, 1, 4)
        q, k, v = qkv[0], qkv[1], qkv[2]
        pq = torch.einsum("bhsd,hdf->bhsf", q, w_phi)
        pk = torch.einsum("bhsd,hdf->bhsf", k, w_phi)
        phi_q = torch.concatenate([_softmax(pq, axis=-1), _softmax(-pq, axis=-1)], axis=-1)
        phi_k = torch.concatenate([_softmax(pk, axis=-1), _softmax(-pk, axis=-1)], axis=-1)
        kv = torch.einsum("bhsf,bhsd->bhfd", phi_k, v)
        z  = torch.einsum("bhsf->bhf", phi_k)
        num = torch.einsum("bhqf,bhfd->bhqd", phi_q, kv)
        den = torch.einsum("bhqf,bhf->bhq", phi_q, z)[..., None] + 1e-6
        o = num / den
        return (lambda x, *d: x.permute(*d))(o, 0, 2, 1, 3).reshape(B, S, D) @ wo

    def _B_ref(x, w1, b1, w2, b2):
        y = _layernorm(x, axis=-1)
        h = _gelu(torch.einsum("bsd,df->bsf", y, w1) + b1)
        return torch.einsum("bsf,fd->bsd", h, w2) + b2

    x = A_x
    xn = _layernorm(x, axis=-1)
    return x + _A_ref(xn, A_wqkv, A_w_phi, A_wo) + _B_ref(xn, B_w1, B_b1, B_w2, B_b2)
```

```asm
; @launch grid=(256,1,1) block=(512,1,1) lds=162816
.amdgcn_target "amdgcn-amd-amdhsa--gfx950"
.text
.globl parallel_sum__linear_kernel_hedgehog__mixer_channel_mlp__prompt_kernel
.p2align 8
.type parallel_sum__linear_kernel_hedgehog__mixer_channel_mlp__prompt_kernel,@function
parallel_sum__linear_kernel_hedgehog__mixer_channel_mlp__prompt_kernel:
    s_cmp_ge_u32 s2, 256
    s_cbranch_scc1 K1_END
    s_load_dwordx4 s[40:43], s[0:1], 0
    s_load_dwordx2 s[44:45], s[0:1], 16
    s_load_dwordx4 s[48:51], s[0:1], 40
    s_load_dwordx4 s[52:55], s[0:1], 80
    s_load_dwordx2 s[84:85], s[0:1], 24
    s_load_dwordx4 s[88:91], s[0:1], 56
    s_load_dwordx2 s[86:87], s[0:1], 72
    s_and_b32 s5, s2, 1
    s_lshl_b32 s5, s5, 2
    s_bfe_u32 s3, s2, 0x20003
    s_add_u32 s5, s5, s3
    s_lshr_b32 s6, s2, 6
    s_lshl_b32 s6, s6, 3
    s_and_b32 s3, s2, 6
    s_add_u32 s6, s6, s3
    s_bfe_u32 s3, s2, 0x10005
    s_add_u32 s6, s6, s3
    v_and_b32 v1, 63, v0
    v_lshrrev_b32 v2, 6, v0
    s_nop 0
    v_readfirstlane_b32 s7, v2
    v_lshrrev_b32 v3, 3, v1
    v_lshl_add_u32 v3, v2, 5, v3
    s_lshl_b32 s3, s5, 8
    v_add_u32 v3, s3, v3
    v_lshlrev_b32 v3, 10, v3
    v_lshrrev_b32 v4, 4, v1
    v_and_b32 v5, 7, v1
    v_xor_b32 v4, v4, v5
    v_lshlrev_b32 v4, 4, v4
    v_xor_b32 v5, 64, v4
    v_add_u32 v96, v3, v4
    v_add_u32 v97, v3, v5
    v_add_u32 v97, 7168, v97
    v_add_u32 v98, 14336, v96
    v_add_u32 v99, 14336, v97
    v_mul_u32_u24 v3, 43, v1
    v_lshrrev_b32 v3, 9, v3
    v_mul_u32_u24 v4, 12, v3
    v_sub_u32 v4, v1, v4
    v_lshl_add_u32 v3, v2, 3, v3
    s_cmp_lt_u32 s6, 16
    s_movk_i32 s37, 2752
    s_cselect_b32 s37, 3072, s37
    s_cselect_b32 s3, 1024, 64
    s_cselect_b32 s4, 64, 192
    s_cselect_b32 s38, 0, 16
    s_sub_u32 s38, s6, s38
    s_mul_i32 s4, s4, s38
    v_mul_lo_u32 v3, v3, s37
    v_lshrrev_b32 v5, 2, v4
    v_mul_lo_u32 v5, v5, s3
    v_and_b32 v4, 3, v4
    v_lshl_add_u32 v4, v4, 4, v5
    v_add3_u32 v100, v3, v4, s4
    s_lshl_b32 s3, s37, 2
    s_sub_u32 s3, s3, 768
    v_add_u32 v101, s3, v100
    s_lshl_b32 s39, s37, 6
    s_lshl_b32 s4, s37, 9
    s_mov_b32 s34, -1
    s_mov_b32 s35, 0xffff
    s_mul_i32 s32, s7, 12288
    s_add_u32 s32, s32, 36864
    s_mul_i32 s33, s7, 1536
    s_waitcnt lgkmcnt(0)
    s_mov_b32 s8, s40
    s_mov_b32 s9, s41
    s_mov_b32 s10, 0x200000
    s_mov_b32 s11, 0x00020000
    s_cmp_lt_u32 s6, 16
    s_cselect_b32 s12, s42, s48
    s_cselect_b32 s13, s43, s49
    s_mov_b32 s14, s4
    s_mov_b32 s15, 0x00020000
    s_cselect_b32 s16, s44, s50
    s_cselect_b32 s17, s45, s51
    s_movk_i32 s3, 2752
    s_cselect_b32 s18, 16384, s3
    s_mov_b32 s19, 0x00020000
    s_mov_b32 s20, s54
    s_mov_b32 s21, s55
    s_mov_b32 s22, 0x760000
    s_mov_b32 s23, 0x00020000
    s_mov_b32 s28, s52
    s_mov_b32 s29, s53
    s_mov_b32 s30, 0x100
    s_mov_b32 s31, 0x00020000
    s_add_u32 s24, s54, 0x800000
    s_addc_u32 s25, s55, 0
    s_mov_b32 s26, 0x118000
    s_mov_b32 s27, 0x00020000
    s_lshl_b32 s4, s7, 24
    s_add_u32 s4, s4, 0x108000
    s_lshl_b32 s3, s5, 13
    s_add_u32 s3, s3, s4
    s_lshl_b32 s46, s6, 8
    s_add_u32 s47, s46, s3
    v_lshl_add_u32 v233, v1, 2, s47
    s_and_b32 s47, s2, 7
    s_lshl_b32 s47, s47, 5
    s_lshr_b32 s60, s2, 3
    s_add_u32 s47, s47, s60
    s_lshl_b32 s47, s47, 8
    s_add_u32 s47, s47, s4
    v_lshl_add_u32 v6, v1, 2, s47
    s_lshl_b32 s47, s6, 2
    s_add_u32 s47, s47, s3
    v_lshl_add_u32 v3, v1, 8, s47
    s_add_u32 s46, s46, s4
    s_lshl_b32 s47, s5, 2
    s_add_u32 s46, s46, s47
    s_sub_u32 s46, s46, 0x3ffc0
    v_lshl_add_u32 v4, v1, 13, s46
    v_cmp_gt_u32 vcc, 32, v1
    v_mov_b32 v5, 0x7f000000
    v_add_u32 v234, 128, v3
    v_cndmask_b32 v4, v4, v3, vcc
    v_cndmask_b32 v233, v6, v233, vcc
    v_cndmask_b32 v234, v5, v234, vcc
    s_cmp_lt_u32 s6, 16
    s_cselect_b32 s3, 40, 0
    s_cselect_b32 s61, 0xffffff, 0
    s_or_b32 s61, s61, 0xffff
    v_cmp_gt_u32 vcc, s3, v1
    s_lshl_b32 s4, s7, 12
    v_mov_b32 v236, s4
    v_cndmask_b32 v235, v5, v4, vcc
    s_cmp_eq_u32 s6, 31
    s_cbranch_scc1 K1_IDLE
    s_and_b32 s3, s6, 7
    s_lshl_b32 s56, s3, 7
    s_mul_i32 s57, s3, s39
    s_lshl_b32 s59, s39, 3
    s_lshl_b32 s3, s5, 4
    s_add_u32 s3, s3, s6
    s_lshl_b32 s3, s3, 3
    s_add_u32 s3, s3, s7
    s_lshl_b32 s3, s3, 1
    s_cmp_lt_u32 s6, 16
    s_cselect_b32 s36, s3, 0x4000
    s_lshl_b32 s3, s36, 10
    v_lshl_add_u32 v6, v1, 5, s3
    buffer_load_dwordx4 v[134:137], v6, s[8:11], 0 offen
    buffer_load_dwordx4 v[138:141], v6, s[8:11], 0 offen offset:16
    s_mov_b32 m0, s32
    s_nop 0
    buffer_load_dwordx4 v96, s[8:11], s56 offen offset:0 lds
    buffer_load_dwordx4 v97, s[8:11], s56 offen offset:1024 lds
    buffer_load_dwordx4 v98, s[8:11], s56 offen offset:2048 lds
    buffer_load_dwordx4 v99, s[8:11], s56 offen offset:3072 lds
    s_mov_b32 m0, s33
    s_mov_b64 exec, s[34:35]
    buffer_load_dwordx4 v100, s[12:15], s57 offen lds
    buffer_load_dwordx4 v101, s[12:15], s57 offen offset:768 lds
    s_mov_b64 exec, -1
    s_add_u32 s56, s56, 128
    s_and_b32 s56, s56, 1023
    s_add_u32 s57, s57, s39
    s_cmp_eq_u32 s57, s59
    s_cselect_b32 s57, 0, s57
    s_add_u32 s3, s32, 4096
    s_add_u32 s4, s33, 12288
    s_mov_b32 m0, s3
    s_nop 0
    buffer_load_dwordx4 v96, s[8:11], s56 offen offset:0 lds
    buffer_load_dwordx4 v97, s[8:11], s56 offen offset:1024 lds
    buffer_load_dwordx4 v98, s[8:11], s56 offen offset:2048 lds
    buffer_load_dwordx4 v99, s[8:11], s56 offen offset:3072 lds
    s_mov_b32 m0, s4
    s_mov_b64 exec, s[34:35]
    buffer_load_dwordx4 v100, s[12:15], s57 offen lds
    buffer_load_dwordx4 v101, s[12:15], s57 offen offset:768 lds
    s_mov_b64 exec, -1
    s_add_u32 s56, s56, 128
    s_and_b32 s56, s56, 1023
    s_add_u32 s57, s57, s39
    s_cmp_eq_u32 s57, s59
    s_cselect_b32 s57, 0, s57
    s_cmp_lt_u32 s6, 16
    s_cbranch_scc0 K1_MISC_MLP
    s_lshl_b32 s3, s38, 10
    v_lshl_add_u32 v3, v1, 4, s3
    s_mov_b32 m0, 161792
    s_nop 0
    buffer_load_dwordx4 v3, s[16:19], 0 offen lds
    s_branch K1_MISC_DONE
K1_MISC_MLP:
    s_mul_i32 s3, s38, 96
    v_add_u32 v3, s3, v0
    v_lshlrev_b32 v3, 1, v3
    buffer_load_ushort v112, v3, s[16:19], 0 offen
K1_MISC_DONE:
    s_lshl_b32 s3, s38, 3
    s_add_u32 s3, s3, s5
    s_lshl_b32 s3, s3, 3
    s_add_u32 s3, s3, s7
    s_lshl_b32 s3, s3, 10
    s_cmp_lt_u32 s6, 16
    s_cselect_b32 s3, s3, 0x1000000
    v_lshl_add_u32 v7, v1, 4, s3
    v_mov_b32 v8, -1
    v_mov_b32 v9, -1
    v_mov_b32 v10, -1
    v_mov_b32 v11, -1
    buffer_store_dwordx4 v[8:11], v7, s[24:27], 0 offen sc1
    v_and_b32 v3, 31, v1
    v_lshlrev_b32 v4, 7, v3
    v_add_u32 v4, s32, v4
    v_bfe_u32 v3, v1, 1, 3
    v_lshrrev_b32 v5, 5, v1
    v_xor_b32 v3, v3, v5
    v_lshlrev_b32 v3, 4, v3
    v_xor_b32 v5, 0, v3
    v_add_u32 v102, v4, v5
    v_xor_b32 v5, 32, v3
    v_add_u32 v103, v4, v5
    v_xor_b32 v5, 64, v3
    v_add_u32 v104, v4, v5
    v_xor_b32 v5, 96, v3
    v_add_u32 v105, v4, v5
    v_lshrrev_b32 v3, 5, v1
    v_bfe_u32 v4, v1, 2, 2
    v_lshl_add_u32 v3, v3, 3, v4
    v_mul_u32_u24 v3, 192, v3
    v_bfe_u32 v4, v1, 4, 1
    v_lshl_add_u32 v3, v4, 5, v3
    v_and_b32 v4, 3, v1
    v_lshl_add_u32 v106, v4, 3, v3
    v_mov_b32 v120, 0
    v_mov_b32 v121, 0
    v_mov_b32 v122, 0
    v_mov_b32 v123, 0
    v_mov_b32 v124, 0
    v_mov_b32 v125, 0
    v_mov_b32 v126, 0
    v_mov_b32 v127, 0
    v_mov_b32 v128, 0
    v_mov_b32 v129, 0
    v_mov_b32 v130, 0
    v_mov_b32 v131, 0
    s_mov_b32 s58, 0x3f803f80
    v_mov_b32 v132, s58
    v_mov_b32 v133, s58
    v_mov_b32 v12, 0
    v_mov_b32 v13, 0
    v_lshrrev_b32 v3, 5, v1
    v_add_u32 v3, s36, v3
    v_lshlrev_b32 v6, 4, v3
    v_and_b32 v3, 31, v1
    v_cmp_eq_u32 vcc, 0, v3
    v_add_u32 v6, 0x100000, v6
    v_mov_b32 v4, 0x1000000
    v_cndmask_b32 v6, v4, v6, vcc
    s_cmp_lt_u32 s6, 16
    s_cbranch_scc0 K1_NOSTAT
    s_waitcnt vmcnt(14)
    v_dot2c_f32_bf16 v12, s58, v134
    v_dot2c_f32_bf16 v13, v134, v134
    v_dot2c_f32_bf16 v12, s58, v135
    v_dot2c_f32_bf16 v13, v135, v135
    v_dot2c_f32_bf16 v12, s58, v136
    v_dot2c_f32_bf16 v13, v136, v136
    v_dot2c_f32_bf16 v12, s58, v137
    v_dot2c_f32_bf16 v13, v137, v137
    v_dot2c_f32_bf16 v12, s58, v138
    v_dot2c_f32_bf16 v13, v138, v138
    v_dot2c_f32_bf16 v12, s58, v139
    v_dot2c_f32_bf16 v13, v139, v139
    v_dot2c_f32_bf16 v12, s58, v140
    v_dot2c_f32_bf16 v13, v140, v140
    v_dot2c_f32_bf16 v12, s58, v141
    v_dot2c_f32_bf16 v13, v141, v141
    s_nop 2
    v_add_f32_dpp v12, v12, v12 row_ror:8 row_mask:0xf bank_mask:0xf
    v_add_f32_dpp v13, v13, v13 row_ror:8 row_mask:0xf bank_mask:0xf
    s_nop 0
    v_add_f32_dpp v12, v12, v12 row_ror:4 row_mask:0xf bank_mask:0xf
    v_add_f32_dpp v13, v13, v13 row_ror:4 row_mask:0xf bank_mask:0xf
    s_nop 0
    v_add_f32_dpp v12, v12, v12 row_ror:2 row_mask:0xf bank_mask:0xf
    v_add_f32_dpp v13, v13, v13 row_ror:2 row_mask:0xf bank_mask:0xf
    s_nop 0
    v_add_f32_dpp v12, v12, v12 row_ror:1 row_mask:0xf bank_mask:0xf
    v_add_f32_dpp v13, v13, v13 row_ror:1 row_mask:0xf bank_mask:0xf
    s_nop 0
    v_mov_b32 v4, v12
    v_mov_b32 v5, v13
    s_nop 1
    v_permlane16_swap_b32 v4, v12
    v_permlane16_swap_b32 v5, v13
    s_nop 1
    v_add_f32 v12, v12, v4
    v_add_f32 v13, v13, v5
    v_mul_f32 v12, 0x3b000000, v12
    v_mul_f32 v4, 0x3b000000, v13
    v_fma_f32 v4, -v12, v12, v4
    v_max_f32 v4, 0, v4
    v_add_f32 v5, 0x3727c5ac, v4
    v_rsq_f32 v14, v5
    s_nop 0
    v_mul_f32 v5, v14, v14
    v_mul_f32 v5, v5, v4
    v_add_f32 v5, 0x3727c5ac, v5
    v_rsq_f32 v5, v5
    v_mul_f32 v15, -v12, v14
    v_mul_f32 v4, v5, v14
    v_mul_f32 v5, -v12, v4
    v_mov_b32 v12, v14
    v_mov_b32 v13, v15
    v_mov_b32 v14, v4
    v_mov_b32 v15, v5
K1_NOSTAT:
    buffer_store_dwordx4 v[12:15], v6, s[24:27], 0 offen sc1
    s_lshl_b32 s3, s5, 3
    s_add_u32 s3, s3, s7
    s_lshl_b32 s3, s3, 9
    s_add_u32 s3, s3, 0x100000
    s_cmp_lt_u32 s6, 16
    s_cselect_b32 s4, 0, 8
    s_add_u32 s3, s3, s4
    v_and_b32 v3, 31, v1
    v_lshl_add_u32 v9, v3, 4, s3
    s_waitcnt vmcnt(9)
    s_barrier
    ds_read_b128 v[88:91], v102 offset:0
    ds_read_b64_tr_b16 v[64:65], v106 offset:0
    ds_read_b64_tr_b16 v[66:67], v106 offset:768
    ds_read_b64_tr_b16 v[68:69], v106 offset:64
    ds_read_b64_tr_b16 v[70:71], v106 offset:832
    ds_read_b64_tr_b16 v[72:73], v106 offset:128
    ds_read_b64_tr_b16 v[74:75], v106 offset:896
    buffer_load_dword v107, v236, s[28:31], 0 offen sc1
    s_waitcnt lgkmcnt(4)
    v_mfma_f32_32x32x16_bf16 v[16:31], v[64:67], v[88:91], 0
    ds_read_b128 v[92:95], v103 offset:0
    ds_read_b64_tr_b16 v[76:77], v106 offset:3072
    ds_read_b64_tr_b16 v[78:79], v106 offset:3840
    s_add_u32 m0, s32, 8192
    s_nop 0
    buffer_load_dwordx4 v96, s[8:11], s56 offen offset:0 lds
    s_waitcnt lgkmcnt(5)
    v_mfma_f32_32x32x16_bf16 v[32:47], v[68:71], v[88:91], 0
    ds_read_b64_tr_b16 v[80:81], v106 offset:3136
    ds_read_b64_tr_b16 v[82:83], v106 offset:3904
    s_waitcnt lgkmcnt(5)
    v_mfma_f32_32x32x16_bf16 v[48:63], v[72:75], v[88:91], 0
    ds_read_b64_tr_b16 v[84:85], v106 offset:3200
    ds_read_b64_tr_b16 v[86:87], v106 offset:3968
    buffer_load_dwordx4 v97, s[8:11], s56 offen offset:1024 lds
    s_cmp_lg_u32 s7, 0
    s_cbranch_scc1 K1_NOCS0
    v_mfma_f32_4x4x4_16b_bf16 v[120:123], v[132:133], v[64:65], v[120:123]
    v_mfma_f32_4x4x4_16b_bf16 v[124:127], v[132:133], v[68:69], v[124:127]
    v_mfma_f32_4x4x4_16b_bf16 v[128:131], v[132:133], v[72:73], v[128:131]
    v_mfma_f32_4x4x4_16b_bf16 v[120:123], v[132:133], v[66:67], v[120:123]
    v_mfma_f32_4x4x4_16b_bf16 v[124:127], v[132:133], v[70:71], v[124:127]
    v_mfma_f32_4x4x4_16b_bf16 v[128:131], v[132:133], v[74:75], v[128:131]
K1_NOCS0:
    s_waitcnt lgkmcnt(4)
    v_mfma_f32_32x32x16_bf16 v[16:31], v[76:79], v[92:95], v[16:31]
    ds_read_b128 v[88:91], v104 offset:0
    ds_read_b64_tr_b16 v[64:65], v106 offset:6144
    ds_read_b64_tr_b16 v[66:67], v106 offset:6912
    buffer_load_dwordx4 v98, s[8:11], s56 offen offset:2048 lds
    s_waitcnt lgkmcnt(5)
    v_mfma_f32_32x32x16_bf16 v[32:47], v[80:83], v[92:95], v[32:47]
    ds_read_b64_tr_b16 v[68:69], v106 offset:6208
    ds_read_b64_tr_b16 v[70:71], v106 offset:6976
    s_waitcnt lgkmcnt(5)
    v_mfma_f32_32x32x16_bf16 v[48:63], v[84:87], v[92:95], v[48:63]
    ds_read_b64_tr_b16 v[72:73], v106 offset:6272
    ds_read_b64_tr_b16 v[74:75], v106 offset:7040
    buffer_load_dwordx4 v99, s[8:11], s56 offen offset:3072 lds
    s_add_u32 s56, s56, 128
    s_and_b32 s56, s56, 1023
    s_add_u32 m0, s33, 24576
    s_cmp_lg_u32 s7, 1
    s_cbranch_scc1 K1_NOCS1
    v_mfma_f32_4x4x4_16b_bf16 v[120:123], v[132:133], v[76:77], v[120:123]
    v_mfma_f32_4x4x4_16b_bf16 v[124:127], v[132:133], v[80:81], v[124:127]
    v_mfma_f32_4x4x4_16b_bf16 v[128:131], v[132:133], v[84:85], v[128:131]
    v_mfma_f32_4x4x4_16b_bf16 v[120:123], v[132:133], v[78:79], v[120:123]
    v_mfma_f32_4x4x4_16b_bf16 v[124:127], v[132:133], v[82:83], v[124:127]
    v_mfma_f32_4x4x4_16b_bf16 v[128:131], v[132:133], v[86:87], v[128:131]
K1_NOCS1:
    s_waitcnt lgkmcnt(4)
    v_mfma_f32_32x32x16_bf16 v[16:31], v[64:67], v[88:91], v[16:31]
    ds_read_b128 v[92:95], v105 offset:0
    ds_read_b64_tr_b16 v[76:77], v106 offset:9216
    ds_read_b64_tr_b16 v[78:79], v106 offset:9984
    s_mov_b64 exec, s[34:35]
    buffer_load_dwordx4 v100, s[12:15], s57 offen offset:0 lds
    s_mov_b64 exec, -1
    s_waitcnt lgkmcnt(5)
    v_mfma_f32_32x32x16_bf16 v[32:47], v[68:71], v[88:91], v[32:47]
    ds_read_b64_tr_b16 v[80:81], v106 offset:9280
    ds_read_b64_tr_b16 v[82:83], v106 offset:10048
    s_waitcnt lgkmcnt(5)
    v_mfma_f32_32x32x16_bf16 v[48:63], v[72:75], v[88:91], v[48:63]
    ds_read_b64_tr_b16 v[84:85], v106 offset:9344
    ds_read_b64_tr_b16 v[86:87], v106 offset:10112
    s_mov_b64 exec, s[34:35]
    buffer_load_dwordx4 v101, s[12:15], s57 offen offset:768 lds
    s_mov_b64 exec, -1
    s_add_u32 s57, s57, s39
    s_cmp_eq_u32 s57, s59
    s_cselect_b32 s57, 0, s57
    s_cmp_lg_u32 s7, 2
    s_cbranch_scc1 K1_NOCS2
    v_mfma_f32_4x4x4_16b_bf16 v[120:123], v[132:133], v[64:65], v[120:123]
    v_mfma_f32_4x4x4_16b_bf16 v[124:127], v[132:133], v[68:69], v[124:127]
    v_mfma_f32_4x4x4_16b_bf16 v[128:131], v[132:133], v[72:73], v[128:131]
    v_mfma_f32_4x4x4_16b_bf16 v[120:123], v[132:133], v[66:67], v[120:123]
    v_mfma_f32_4x4x4_16b_bf16 v[124:127], v[132:133], v[70:71], v[124:127]
    v_mfma_f32_4x4x4_16b_bf16 v[128:131], v[132:133], v[74:75], v[128:131]
K1_NOCS2:
    s_waitcnt lgkmcnt(4)
    v_mfma_f32_32x32x16_bf16 v[16:31], v[76:79], v[92:95], v[16:31]
    s_waitcnt vmcnt(10) lgkmcnt(0)
    s_barrier
    ds_read_b128 v[88:91], v102 offset:4096
    ds_read_b64_tr_b16 v[64:65], v106 offset:12288
    ds_read_b64_tr_b16 v[66:67], v106 offset:13056
    v_mfma_f32_32x32x16_bf16 v[32:47], v[80:83], v[92:95], v[32:47]
    ds_read_b64_tr_b16 v[68:69], v106 offset:12352
    ds_read_b64_tr_b16 v[70:71], v106 offset:13120
    v_mfma_f32_32x32x16_bf16 v[48:63], v[84:87], v[92:95], v[48:63]
    ds_read_b64_tr_b16 v[72:73], v106 offset:12416
    ds_read_b64_tr_b16 v[74:75], v106 offset:13184
    s_add_u32 m0, s32, 0
    s_nop 0
    buffer_load_dwordx4 v96, s[8:11], s56 offen offset:0 lds
    s_cmp_lg_u32 s7, 3
    s_cbranch_scc1 K1_NOCS3
    v_mfma_f32_4x4x4_16b_bf16 v[120:123], v[132:133], v[76:77], v[120:123]
    v_mfma_f32_4x4x4_16b_bf16 v[124:127], v[132:133], v[80:81], v[124:127]
    v_mfma_f32_4x4x4_16b_bf16 v[128:131], v[132:133], v[84:85], v[128:131]
    v_mfma_f32_4x4x4_16b_bf16 v[120:123], v[132:133], v[78:79], v[120:123]
    v_mfma_f32_4x4x4_16b_bf16 v[124:127], v[132:133], v[82:83], v[124:127]
    v_mfma_f32_4x4x4_16b_bf16 v[128:131], v[132:133], v[86:87], v[128:131]
K1_NOCS3:
    s_waitcnt lgkmcnt(4)
    v_mfma_f32_32x32x16_bf16 v[16:31], v[64:67], v[88:91], v[16:31]
    ds_read_b128 v[92:95], v103 offset:4096
    ds_read_b64_tr_b16 v[76:77], v106 offset:15360
    ds_read_b64_tr_b16 v[78:79], v106 offset:16128
    buffer_load_dwordx4 v97, s[8:11], s56 offen offset:1024 lds
    s_waitcnt lgkmcnt(5)
    v_mfma_f32_32x32x16_bf16 v[32:47], v[68:71], v[88:91], v[32:47]
    ds_read_b64_tr_b16 v[80:81], v106 offset:15424
    ds_read_b64_tr_b16 v[82:83], v106 offset:16192
    s_waitcnt lgkmcnt(5)
    v_mfma_f32_32x32x16_bf16 v[48:63], v[72:75], v[88:91], v[48:63]
    ds_read_b64_tr_b16 v[84:85], v106 offset:15488
    ds_read_b64_tr_b16 v[86:87], v106 offset:16256
    buffer_load_dwordx4 v98, s[8:11], s56 offen offset:2048 lds
    s_cmp_lg_u32 s7, 4
    s_cbranch_scc1 K1_NOCS4
    v_mfma_f32_4x4x4_16b_bf16 v[120:123], v[132:133], v[64:65], v[120:123]
    v_mfma_f32_4x4x4_16b_bf16 v[124:127], v[132:133], v[68:69], v[124:127]
    v_mfma_f32_4x4x4_16b_bf16 v[128:131], v[132:133], v[72:73], v[128:131]
    v_mfma_f32_4x4x4_16b_bf16 v[120:123], v[132:133], v[66:67], v[120:123]
    v_mfma_f32_4x4x4_16b_bf16 v[124:127], v[132:133], v[70:71], v[124:127]
    v_mfma_f32_4x4x4_16b_bf16 v[128:131], v[132:133], v[74:75], v[128:131]
K1_NOCS4:
    s_waitcnt lgkmcnt(4)
    v_mfma_f32_32x32x16_bf16 v[16:31], v[76:79], v[92:95], v[16:31]
    ds_read_b128 v[88:91], v104 offset:4096
    ds_read_b64_tr_b16 v[64:65], v106 offset:18432
    ds_read_b64_tr_b16 v[66:67], v106 offset:19200
    buffer_load_dwordx4 v99, s[8:11], s56 offen offset:3072 lds
    s_add_u32 s56, s56, 128
    s_and_b32 s56, s56, 1023
    s_add_u32 m0, s33, 0
    s_waitcnt lgkmcnt(5)
    v_mfma_f32_32x32x16_bf16 v[32:47], v[80:83], v[92:95], v[32:47]
    ds_read_b64_tr_b16 v[68:69], v106 offset:18496
    ds_read_b64_tr_b16 v[70:71], v106 offset:19264
    s_waitcnt lgkmcnt(5)
    v_mfma_f32_32x32x16_bf16 v[48:63], v[84:87], v[92:95], v[48:63]
    ds_read_b64_tr_b16 v[72:73], v106 offset:18560
    ds_read_b64_tr_b16 v[74:75], v106 offset:19328
    s_mov_b64 exec, s[34:35]
    buffer_load_dwordx4 v100, s[12:15], s57 offen offset:0 lds
    s_mov_b64 exec, -1
    s_cmp_lg_u32 s7, 5
    s_cbranch_scc1 K1_NOCS5
    v_mfma_f32_4x4x4_16b_bf16 v[120:123], v[132:133], v[76:77], v[120:123]
    v_mfma_f32_4x4x4_16b_bf16 v[124:127], v[132:133], v[80:81], v[124:127]
    v_mfma_f32_4x4x4_16b_bf16 v[128:131], v[132:133], v[84:85], v[128:131]
    v_mfma_f32_4x4x4_16b_bf16 v[120:123], v[132:133], v[78:79], v[120:123]
    v_mfma_f32_4x4x4_16b_bf16 v[124:127], v[132:133], v[82:83], v[124:127]
    v_mfma_f32_4x4x4_16b_bf16 v[128:131], v[132:133], v[86:87], v[128:131]
K1_NOCS5:
    s_waitcnt lgkmcnt(4)
    v_mfma_f32_32x32x16_bf16 v[16:31], v[64:67], v[88:91], v[16:31]
    ds_read_b128 v[92:95], v105 offset:4096
    ds_read_b64_tr_b16 v[76:77], v106 offset:21504
    ds_read_b64_tr_b16 v[78:79], v106 offset:22272
    s_mov_b64 exec, s[34:35]
    buffer_load_dwordx4 v101, s[12:15], s57 offen offset:768 lds
    s_mov_b64 exec, -1
    s_add_u32 s57, s57, s39
    s_cmp_eq_u32 s57, s59
    s_cselect_b32 s57, 0, s57
    s_waitcnt lgkmcnt(5)
    v_mfma_f32_32x32x16_bf16 v[32:47], v[68:71], v[88:91], v[32:47]
    ds_read_b64_tr_b16 v[80:81], v106 offset:21568
    ds_read_b64_tr_b16 v[82:83], v106 offset:22336
    s_waitcnt lgkmcnt(5)
    v_mfma_f32_32x32x16_bf16 v[48:63], v[72:75], v[88:91], v[48:63]
    ds_read_b64_tr_b16 v[84:85], v106 offset:21632
    ds_read_b64_tr_b16 v[86:87], v106 offset:22400
    s_cmp_lg_u32 s7, 6
    s_cbranch_scc1 K1_NOCS6
    v_mfma_f32_4x4x4_16b_bf16 v[120:123], v[132:133], v[64:65], v[120:123]
    v_mfma_f32_4x4x4_16b_bf16 v[124:127], v[132:133], v[68:69], v[124:127]
    v_mfma_f32_4x4x4_16b_bf16 v[128:131], v[132:133], v[72:73], v[128:131]
    v_mfma_f32_4x4x4_16b_bf16 v[120:123], v[132:133], v[66:67], v[120:123]
    v_mfma_f32_4x4x4_16b_bf16 v[124:127], v[132:133], v[70:71], v[124:127]
    v_mfma_f32_4x4x4_16b_bf16 v[128:131], v[132:133], v[74:75], v[128:131]
K1_NOCS6:
    s_waitcnt lgkmcnt(4)
    v_mfma_f32_32x32x16_bf16 v[16:31], v[76:79], v[92:95], v[16:31]
    s_waitcnt vmcnt(6) lgkmcnt(0)
    s_barrier
    ds_read_b128 v[88:91], v102 offset:8192
    ds_read_b64_tr_b16 v[64:65], v106 offset:24576
    ds_read_b64_tr_b16 v[66:67], v106 offset:25344
    v_readfirstlane_b32 s36, v107
    s_or_b32 s3, s36, s7
    s_cbranch_scc0 K1_NPOLL
K1_NOK:
    buffer_store_dword v107, v235, s[24:27], 0 offen sc1
    v_mfma_f32_32x32x16_bf16 v[32:47], v[80:83], v[92:95], v[32:47]
    ds_read_b64_tr_b16 v[68:69], v106 offset:24640
    ds_read_b64_tr_b16 v[70:71], v106 offset:25408
    v_mfma_f32_32x32x16_bf16 v[48:63], v[84:87], v[92:95], v[48:63]
    ds_read_b64_tr_b16 v[72:73], v106 offset:24704
    ds_read_b64_tr_b16 v[74:75], v106 offset:25472
    s_add_u32 m0, s32, 4096
    s_nop 0
    buffer_load_dwordx4 v96, s[8:11], s56 offen offset:0 lds
    s_cmp_lg_u32 s7, 7
    s_cbranch_scc1 K1_NOCS7
    v_mfma_f32_4x4x4_16b_bf16 v[120:123], v[132:133], v[76:77], v[120:123]
    v_mfma_f32_4x4x4_16b_bf16 v[124:127], v[132:133], v[80:81], v[124:127]
    v_mfma_f32_4x4x4_16b_bf16 v[128:131], v[132:133], v[84:85], v[128:131]
    v_mfma_f32_4x4x4_16b_bf16 v[120:123], v[132:133], v[78:79], v[120:123]
    v_mfma_f32_4x4x4_16b_bf16 v[124:127], v[132:133], v[82:83], v[124:127]
    v_mfma_f32_4x4x4_16b_bf16 v[128:131], v[132:133], v[86:87], v[128:131]
K1_NOCS7:
    s_waitcnt lgkmcnt(4)
    v_mfma_f32_32x32x16_bf16 v[16:31], v[64:67], v[88:91], v[16:31]
    ds_read_b128 v[92:95], v103 offset:8192
    ds_read_b64_tr_b16 v[76:77], v106 offset:27648
    ds_read_b64_tr_b16 v[78:79], v106 offset:28416
    buffer_load_dwordx4 v97, s[8:11], s56 offen offset:1024 lds
    s_waitcnt lgkmcnt(5)
    v_mfma_f32_32x32x16_bf16 v[32:47], v[68:71], v[88:91], v[32:47]
    ds_read_b64_tr_b16 v[80:81], v106 offset:27712
    ds_read_b64_tr_b16 v[82:83], v106 offset:28480
    s_waitcnt lgkmcnt(5)
    v_mfma_f32_32x32x16_bf16 v[48:63], v[72:75], v[88:91], v[48:63]
    ds_read_b64_tr_b16 v[84:85], v106 offset:27776
    ds_read_b64_tr_b16 v[86:87], v106 offset:28544
    buffer_load_dwordx4 v98, s[8:11], s56 offen offset:2048 lds
    s_cmp_lg_u32 s7, 0
    s_cbranch_scc1 K1_NOCS8
    v_mfma_f32_4x4x4_16b_bf16 v[120:123], v[132:133], v[64:65], v[120:123]
    v_mfma_f32_4x4x4_16b_bf16 v[124:127], v[132:133], v[68:69], v[124:127]
    v_mfma_f32_4x4x4_16b_bf16 v[128:131], v[132:133], v[72:73], v[128:131]
    v_mfma_f32_4x4x4_16b_bf16 v[120:123], v[132:133], v[66:67], v[120:123]
    v_mfma_f32_4x4x4_16b_bf16 v[124:127], v[132:133], v[70:71], v[124:127]
    v_mfma_f32_4x4x4_16b_bf16 v[128:131], v[132:133], v[74:75], v[128:131]
K1_NOCS8:
    s_waitcnt lgkmcnt(4)
    v_mfma_f32_32x32x16_bf16 v[16:31], v[76:79], v[92:95], v[16:31]
    ds_read_b128 v[88:91], v104 offset:8192
    ds_read_b64_tr_b16 v[64:65], v106 offset:30720
    ds_read_b64_tr_b16 v[66:67], v106 offset:31488
    buffer_load_dwordx4 v99, s[8:11], s56 offen offset:3072 lds
    s_add_u32 s56, s56, 128
    s_and_b32 s56, s56, 1023
    s_add_u32 m0, s33, 12288
    s_waitcnt lgkmcnt(5)
    v_mfma_f32_32x32x16_bf16 v[32:47], v[80:83], v[92:95], v[32:47]
    ds_read_b64_tr_b16 v[68:69], v106 offset:30784
    ds_read_b64_tr_b16 v[70:71], v106 offset:31552
    s_waitcnt lgkmcnt(5)
    v_mfma_f32_32x32x16_bf16 v[48:63], v[84:87], v[92:95], v[48:63]
    ds_read_b64_tr_b16 v[72:73], v106 offset:30848
    ds_read_b64_tr_b16 v[74:75], v106 offset:31616
    s_mov_b64 exec, s[34:35]
    buffer_load_dwordx4 v100, s[12:15], s57 offen offset:0 lds
    s_mov_b64 exec, -1
    s_cmp_lg_u32 s7, 1
    s_cbranch_scc1 K1_NOCS9
    v_mfma_f32_4x4x4_16b_bf16 v[120:123], v[132:133], v[76:77], v[120:123]
    v_mfma_f32_4x4x4_16b_bf16 v[124:127], v[132:133], v[80:81], v[124:127]
    v_mfma_f32_4x4x4_16b_bf16 v[128:131], v[132:133], v[84:85], v[128:131]
    v_mfma_f32_4x4x4_16b_bf16 v[120:123], v[132:133], v[78:79], v[120:123]
    v_mfma_f32_4x4x4_16b_bf16 v[124:127], v[132:133], v[82:83], v[124:127]
    v_mfma_f32_4x4x4_16b_bf16 v[128:131], v[132:133], v[86:87], v[128:131]
K1_NOCS9:
    s_waitcnt lgkmcnt(4)
    v_mfma_f32_32x32x16_bf16 v[16:31], v[64:67], v[88:91], v[16:31]
    ds_read_b128 v[92:95], v105 offset:8192
    ds_read_b64_tr_b16 v[76:77], v106 offset:33792
    ds_read_b64_tr_b16 v[78:79], v106 offset:34560
    s_mov_b64 exec, s[34:35]
    buffer_load_dwordx4 v101, s[12:15], s57 offen offset:768 lds
    s_mov_b64 exec, -1
    s_add_u32 s57, s57, s39
    s_cmp_eq_u32 s57, s59
    s_cselect_b32 s57, 0, s57
    s_waitcnt lgkmcnt(5)
    v_mfma_f32_32x32x16_bf16 v[32:47], v[68:71], v[88:91], v[32:47]
    ds_read_b64_tr_b16 v[80:81], v106 offset:33856
    ds_read_b64_tr_b16 v[82:83], v106 offset:34624
    s_waitcnt lgkmcnt(5)
    v_mfma_f32_32x32x16_bf16 v[48:63], v[72:75], v[88:91], v[48:63]
    ds_read_b64_tr_b16 v[84:85], v106 offset:33920
    ds_read_b64_tr_b16 v[86:87], v106 offset:34688
    s_cmp_lg_u32 s7, 2
    s_cbranch_scc1 K1_NOCS10
    v_mfma_f32_4x4x4_16b_bf16 v[120:123], v[132:133], v[64:65], v[120:123]
    v_mfma_f32_4x4x4_16b_bf16 v[124:127], v[132:133], v[68:69], v[124:127]
    v_mfma_f32_4x4x4_16b_bf16 v[128:131], v[132:133], v[72:73], v[128:131]
    v_mfma_f32_4x4x4_16b_bf16 v[120:123], v[132:133], v[66:67], v[120:123]
    v_mfma_f32_4x4x4_16b_bf16 v[124:127], v[132:133], v[70:71], v[124:127]
    v_mfma_f32_4x4x4_16b_bf16 v[128:131], v[132:133], v[74:75], v[128:131]
K1_NOCS10:
    s_waitcnt lgkmcnt(4)
    v_mfma_f32_32x32x16_bf16 v[16:31], v[76:79], v[92:95], v[16:31]
    s_waitcnt vmcnt(7) lgkmcnt(0)
    s_barrier
    ds_read_b128 v[88:91], v102 offset:0
    ds_read_b64_tr_b16 v[64:65], v106 offset:0
    ds_read_b64_tr_b16 v[66:67], v106 offset:768
    v_mfma_f32_32x32x16_bf16 v[32:47], v[80:83], v[92:95], v[32:47]
    ds_read_b64_tr_b16 v[68:69], v106 offset:64
    ds_read_b64_tr_b16 v[70:71], v106 offset:832
    v_mfma_f32_32x32x16_bf16 v[48:63], v[84:87], v[92:95], v[48:63]
    ds_read_b64_tr_b16 v[72:73], v106 offset:128
    ds_read_b64_tr_b16 v[74:75], v106 offset:896
    s_add_u32 m0, s32, 8192
    s_nop 0
    buffer_load_dwordx4 v96, s[8:11], s56 offen offset:0 lds
    s_cmp_lg_u32 s7, 3
    s_cbranch_scc1 K1_NOCS11
    v_mfma_f32_4x4x4_16b_bf16 v[120:123], v[132:133], v[76:77], v[120:123]
    v_mfma_f32_4x4x4_16b_bf16 v[124:127], v[132:133], v[80:81], v[124:127]
    v_mfma_f32_4x4x4_16b_bf16 v[128:131], v[132:133], v[84:85], v[128:131]
    v_mfma_f32_4x4x4_16b_bf16 v[120:123], v[132:133], v[78:79], v[120:123]
    v_mfma_f32_4x4x4_16b_bf16 v[124:127], v[132:133], v[82:83], v[124:127]
    v_mfma_f32_4x4x4_16b_bf16 v[128:131], v[132:133], v[86:87], v[128:131]
K1_NOCS11:
    s_waitcnt lgkmcnt(4)
    v_mfma_f32_32x32x16_bf16 v[16:31], v[64:67], v[88:91], v[16:31]
    ds_read_b128 v[92:95], v103 offset:0
    ds_read_b64_tr_b16 v[76:77], v106 offset:3072
    ds_read_b64_tr_b16 v[78:79], v106 offset:3840
    buffer_load_dwordx4 v97, s[8:11], s56 offen offset:1024 lds
    s_waitcnt lgkmcnt(5)
    v_mfma_f32_32x32x16_bf16 v[32:47], v[68:71], v[88:91], v[32:47]
    ds_read_b64_tr_b16 v[80:81], v106 offset:3136
    ds_read_b64_tr_b16 v[82:83], v106 offset:3904
    s_waitcnt lgkmcnt(5)
    v_mfma_f32_32x32x16_bf16 v[48:63], v[72:75], v[88:91], v[48:63]
    ds_read_b64_tr_b16 v[84:85], v106 offset:3200
    ds_read_b64_tr_b16 v[86:87], v106 offset:3968
    buffer_load_dwordx4 v98, s[8:11], s56 offen offset:2048 lds
    s_cmp_lg_u32 s7, 4
    s_cbranch_scc1 K1_NOCS12
    v_mfma_f32_4x4x4_16b_bf16 v[120:123], v[132:133], v[64:65], v[120:123]
    v_mfma_f32_4x4x4_16b_bf16 v[124:127], v[132:133], v[68:69], v[124:127]
    v_mfma_f32_4x4x4_16b_bf16 v[128:131], v[132:133], v[72:73], v[128:131]
    v_mfma_f32_4x4x4_16b_bf16 v[120:123], v[132:133], v[66:67], v[120:123]
    v_mfma_f32_4x4x4_16b_bf16 v[124:127], v[132:133], v[70:71], v[124:127]
    v_mfma_f32_4x4x4_16b_bf16 v[128:131], v[132:133], v[74:75], v[128:131]
K1_NOCS12:
    s_waitcnt lgkmcnt(4)
    v_mfma_f32_32x32x16_bf16 v[16:31], v[76:79], v[92:95], v[16:31]
    ds_read_b128 v[88:91], v104 offset:0
    ds_read_b64_tr_b16 v[64:65], v106 offset:6144
    ds_read_b64_tr_b16 v[66:67], v106 offset:6912
    buffer_load_dwordx4 v99, s[8:11], s56 offen offset:3072 lds
    s_add_u32 s56, s56, 128
    s_and_b32 s56, s56, 1023
    s_add_u32 m0, s33, 24576
    s_waitcnt lgkmcnt(5)
    v_mfma_f32_32x32x16_bf16 v[32:47], v[80:83], v[92:95], v[32:47]
    ds_read_b64_tr_b16 v[68:69], v106 offset:6208
    ds_read_b64_tr_b16 v[70:71], v106 offset:6976
    s_waitcnt lgkmcnt(5)
    v_mfma_f32_32x32x16_bf16 v[48:63], v[84:87], v[92:95], v[48:63]
    ds_read_b64_tr_b16 v[72:73], v106 offset:6272
    ds_read_b64_tr_b16 v[74:75], v106 offset:7040
    s_mov_b64 exec, s[34:35]
    buffer_load_dwordx4 v100, s[12:15], s57 offen offset:0 lds
    s_mov_b64 exec, -1
    s_cmp_lg_u32 s7, 5
    s_cbranch_scc1 K1_NOCS13
    v_mfma_f32_4x4x4_16b_bf16 v[120:123], v[132:133], v[76:77], v[120:123]
    v_mfma_f32_4x4x4_16b_bf16 v[124:127], v[132:133], v[80:81], v[124:127]
    v_mfma_f32_4x4x4_16b_bf16 v[128:131], v[132:133], v[84:85], v[128:131]
    v_mfma_f32_4x4x4_16b_bf16 v[120:123], v[132:133], v[78:79], v[120:123]
    v_mfma_f32_4x4x4_16b_bf16 v[124:127], v[132:133], v[82:83], v[124:127]
    v_mfma_f32_4x4x4_16b_bf16 v[128:131], v[132:133], v[86:87], v[128:131]
K1_NOCS13:
    s_waitcnt lgkmcnt(4)
    v_mfma_f32_32x32x16_bf16 v[16:31], v[64:67], v[88:91], v[16:31]
    ds_read_b128 v[92:95], v105 offset:0
    ds_read_b64_tr_b16 v[76:77], v106 offset:9216
    ds_read_b64_tr_b16 v[78:79], v106 offset:9984
    s_mov_b64 exec, s[34:35]
    buffer_load_dwordx4 v101, s[12:15], s57 offen offset:768 lds
    s_mov_b64 exec, -1
    s_add_u32 s57, s57, s39
    s_cmp_eq_u32 s57, s59
    s_cselect_b32 s57, 0, s57
    s_waitcnt lgkmcnt(5)
    v_mfma_f32_32x32x16_bf16 v[32:47], v[68:71], v[88:91], v[32:47]
    ds_read_b64_tr_b16 v[80:81], v106 offset:9280
    ds_read_b64_tr_b16 v[82:83], v106 offset:10048
    s_waitcnt lgkmcnt(5)
    v_mfma_f32_32x32x16_bf16 v[48:63], v[72:75], v[88:91], v[48:63]
    ds_read_b64_tr_b16 v[84:85], v106 offset:9344
    ds_read_b64_tr_b16 v[86:87], v106 offset:10112
    s_cmp_lg_u32 s7, 6
    s_cbranch_scc1 K1_NOCS14
    v_mfma_f32_4x4x4_16b_bf16 v[120:123], v[132:133], v[64:65], v[120:123]
    v_mfma_f32_4x4x4_16b_bf16 v[124:127], v[132:133], v[68:69], v[124:127]
    v_mfma_f32_4x4x4_16b_bf16 v[128:131], v[132:133], v[72:73], v[128:131]
    v_mfma_f32_4x4x4_16b_bf16 v[120:123], v[132:133], v[66:67], v[120:123]
    v_mfma_f32_4x4x4_16b_bf16 v[124:127], v[132:133], v[70:71], v[124:127]
    v_mfma_f32_4x4x4_16b_bf16 v[128:131], v[132:133], v[74:75], v[128:131]
K1_NOCS14:
    s_waitcnt lgkmcnt(4)
    v_mfma_f32_32x32x16_bf16 v[16:31], v[76:79], v[92:95], v[16:31]
    s_waitcnt vmcnt(6) lgkmcnt(0)
    s_barrier
    ds_read_b128 v[88:91], v102 offset:4096
    ds_read_b64_tr_b16 v[64:65], v106 offset:12288
    ds_read_b64_tr_b16 v[66:67], v106 offset:13056
    v_mfma_f32_32x32x16_bf16 v[32:47], v[80:83], v[92:95], v[32:47]
    ds_read_b64_tr_b16 v[68:69], v106 offset:12352
    ds_read_b64_tr_b16 v[70:71], v106 offset:13120
    v_mfma_f32_32x32x16_bf16 v[48:63], v[84:87], v[92:95], v[48:63]
    ds_read_b64_tr_b16 v[72:73], v106 offset:12416
    ds_read_b64_tr_b16 v[74:75], v106 offset:13184
    s_add_u32 m0, s32, 0
    s_nop 0
    buffer_load_dwordx4 v96, s[8:11], s56 offen offset:0 lds
    s_cmp_lg_u32 s7, 7
    s_cbranch_scc1 K1_NOCS15
    v_mfma_f32_4x4x4_16b_bf16 v[120:123], v[132:133], v[76:77], v[120:123]
    v_mfma_f32_4x4x4_16b_bf16 v[124:127], v[132:133], v[80:81], v[124:127]
    v_mfma_f32_4x4x4_16b_bf16 v[128:131], v[132:133], v[84:85], v[128:131]
    v_mfma_f32_4x4x4_16b_bf16 v[120:123], v[132:133], v[78:79], v[120:123]
    v_mfma_f32_4x4x4_16b_bf16 v[124:127], v[132:133], v[82:83], v[124:127]
    v_mfma_f32_4x4x4_16b_bf16 v[128:131], v[132:133], v[86:87], v[128:131]
K1_NOCS15:
    s_waitcnt lgkmcnt(4)
    v_mfma_f32_32x32x16_bf16 v[16:31], v[64:67], v[88:91], v[16:31]
    ds_read_b128 v[92:95], v103 offset:4096
    ds_read_b64_tr_b16 v[76:77], v106 offset:15360
    ds_read_b64_tr_b16 v[78:79], v106 offset:16128
    buffer_load_dwordx4 v97, s[8:11], s56 offen offset:1024 lds
    s_waitcnt lgkmcnt(5)
    v_mfma_f32_32x32x16_bf16 v[32:47], v[68:71], v[88:91], v[32:47]
    ds_read_b64_tr_b16 v[80:81], v106 offset:15424
    ds_read_b64_tr_b16 v[82:83], v106 offset:16192
    s_waitcnt lgkmcnt(5)
    v_mfma_f32_32x32x16_bf16 v[48:63], v[72:75], v[88:91], v[48:63]
    ds_read_b64_tr_b16 v[84:85], v106 offset:15488
    ds_read_b64_tr_b16 v[86:87], v106 offset:16256
    buffer_load_dwordx4 v98, s[8:11], s56 offen offset:2048 lds
    s_cmp_lg_u32 s7, 0
    s_cbranch_scc1 K1_NOCS16
    v_mfma_f32_4x4x4_16b_bf16 v[120:123], v[132:133], v[64:65], v[120:123]
    v_mfma_f32_4x4x4_16b_bf16 v[124:127], v[132:133], v[68:69], v[124:127]
    v_mfma_f32_4x4x4_16b_bf16 v[128:131], v[132:133], v[72:73], v[128:131]
    v_mfma_f32_4x4x4_16b_bf16 v[120:123], v[132:133], v[66:67], v[120:123]
    v_mfma_f32_4x4x4_16b_bf16 v[124:127], v[132:133], v[70:71], v[124:127]
    v_mfma_f32_4x4x4_16b_bf16 v[128:131], v[132:133], v[74:75], v[128:131]
K1_NOCS16:
    s_waitcnt lgkmcnt(4)
    v_mfma_f32_32x32x16_bf16 v[16:31], v[76:79], v[92:95], v[16:31]
    ds_read_b128 v[88:91], v104 offset:4096
    ds_read_b64_tr_b16 v[64:65], v106 offset:18432
    ds_read_b64_tr_b16 v[66:67], v106 offset:19200
    buffer_load_dwordx4 v99, s[8:11], s56 offen offset:3072 lds
    s_add_u32 s56, s56, 128
    s_and_b32 s56, s56, 1023
    s_add_u32 m0, s33, 0
    s_waitcnt lgkmcnt(5)
    v_mfma_f32_32x32x16_bf16 v[32:47], v[80:83], v[92:95], v[32:47]
    ds_read_b64_tr_b16 v[68:69], v106 offset:18496
    ds_read_b64_tr_b16 v[70:71], v106 offset:19264
    s_waitcnt lgkmcnt(5)
    v_mfma_f32_32x32x16_bf16 v[48:63], v[84:87], v[92:95], v[48:63]
    ds_read_b64_tr_b16 v[72:73], v106 offset:18560
    ds_read_b64_tr_b16 v[74:75], v106 offset:19328
    s_mov_b64 exec, s[34:35]
    buffer_load_dwordx4 v100, s[12:15], s57 offen offset:0 lds
    s_mov_b64 exec, -1
    s_cmp_lg_u32 s7, 1
    s_cbranch_scc1 K1_NOCS17
    v_mfma_f32_4x4x4_16b_bf16 v[120:123], v[132:133], v[76:77], v[120:123]
    v_mfma_f32_4x4x4_16b_bf16 v[124:127], v[132:133], v[80:81], v[124:127]
    v_mfma_f32_4x4x4_16b_bf16 v[128:131], v[132:133], v[84:85], v[128:131]
    v_mfma_f32_4x4x4_16b_bf16 v[120:123], v[132:133], v[78:79], v[120:123]
    v_mfma_f32_4x4x4_16b_bf16 v[124:127], v[132:133], v[82:83], v[124:127]
    v_mfma_f32_4x4x4_16b_bf16 v[128:131], v[132:133], v[86:87], v[128:131]
K1_NOCS17:
    s_waitcnt lgkmcnt(4)
    v_mfma_f32_32x32x16_bf16 v[16:31], v[64:67], v[88:91], v[16:31]
    ds_read_b128 v[92:95], v105 offset:4096
    ds_read_b64_tr_b16 v[76:77], v106 offset:21504
    ds_read_b64_tr_b16 v[78:79], v106 offset:22272
    s_mov_b64 exec, s[34:35]
    buffer_load_dwordx4 v101, s[12:15], s57 offen offset:768 lds
    s_mov_b64 exec, -1
    s_add_u32 s57, s57, s39
    s_cmp_eq_u32 s57, s59
    s_cselect_b32 s57, 0, s57
    s_waitcnt lgkmcnt(5)
    v_mfma_f32_32x32x16_bf16 v[32:47], v[68:71], v[88:91], v[32:47]
    ds_read_b64_tr_b16 v[80:81], v106 offset:21568
    ds_read_b64_tr_b16 v[82:83], v106 offset:22336
    s_waitcnt lgkmcnt(5)
    v_mfma_f32_32x32x16_bf16 v[48:63], v[72:75], v[88:91], v[48:63]
    ds_read_b64_tr_b16 v[84:85], v106 offset:21632
    ds_read_b64_tr_b16 v[86:87], v106 offset:22400
    s_cmp_lg_u32 s7, 2
    s_cbranch_scc1 K1_NOCS18
    v_mfma_f32_4x4x4_16b_bf16 v[120:123], v[132:133], v[64:65], v[120:123]
    v_mfma_f32_4x4x4_16b_bf16 v[124:127], v[132:133], v[68:69], v[124:127]
    v_mfma_f32_4x4x4_16b_bf16 v[128:131], v[132:133], v[72:73], v[128:131]
    v_mfma_f32_4x4x4_16b_bf16 v[120:123], v[132:133], v[66:67], v[120:123]
    v_mfma_f32_4x4x4_16b_bf16 v[124:127], v[132:133], v[70:71], v[124:127]
    v_mfma_f32_4x4x4_16b_bf16 v[128:131], v[132:133], v[74:75], v[128:131]
K1_NOCS18:
    s_waitcnt lgkmcnt(4)
    v_mfma_f32_32x32x16_bf16 v[16:31], v[76:79], v[92:95], v[16:31]
    s_waitcnt vmcnt(6) lgkmcnt(0)
    s_barrier
    ds_read_b128 v[88:91], v102 offset:8192
    ds_read_b64_tr_b16 v[64:65], v106 offset:24576
    ds_read_b64_tr_b16 v[66:67], v106 offset:25344
    v_mfma_f32_32x32x16_bf16 v[32:47], v[80:83], v[92:95], v[32:47]
    ds_read_b64_tr_b16 v[68:69], v106 offset:24640
    ds_read_b64_tr_b16 v[70:71], v106 offset:25408
    v_mfma_f32_32x32x16_bf16 v[48:63], v[84:87], v[92:95], v[48:63]
    ds_read_b64_tr_b16 v[72:73], v106 offset:24704
    ds_read_b64_tr_b16 v[74:75], v106 offset:25472
    s_add_u32 m0, s32, 4096
    s_nop 0
    buffer_load_dwordx4 v96, s[8:11], s56 offen offset:0 lds
    s_cmp_lg_u32 s7, 3
    s_cbranch_scc1 K1_NOCS19
    v_mfma_f32_4x4x4_16b_bf16 v[120:123], v[132:133], v[76:77], v[120:123]
    v_mfma_f32_4x4x4_16b_bf16 v[124:127], v[132:133], v[80:81], v[124:127]
    v_mfma_f32_4x4x4_16b_bf16 v[128:131], v[132:133], v[84:85], v[128:131]
    v_mfma_f32_4x4x4_16b_bf16 v[120:123], v[132:133], v[78:79], v[120:123]
    v_mfma_f32_4x4x4_16b_bf16 v[124:127], v[132:133], v[82:83], v[124:127]
    v_mfma_f32_4x4x4_16b_bf16 v[128:131], v[132:133], v[86:87], v[128:131]
K1_NOCS19:
    s_waitcnt lgkmcnt(4)
    v_mfma_f32_32x32x16_bf16 v[16:31], v[64:67], v[88:91], v[16:31]
    ds_read_b128 v[92:95], v103 offset:8192
    ds_read_b64_tr_b16 v[76:77], v106 offset:27648
    ds_read_b64_tr_b16 v[78:79], v106 offset:28416
    buffer_load_dwordx4 v97, s[8:11], s56 offen offset:1024 lds
    s_waitcnt lgkmcnt(5)
    v_mfma_f32_32x32x16_bf16 v[32:47], v[68:71], v[88:91], v[32:47]
    ds_read_b64_tr_b16 v[80:81], v106 offset:27712
    ds_read_b64_tr_b16 v[82:83], v106 offset:28480
    s_waitcnt lgkmcnt(5)
    v_mfma_f32_32x32x16_bf16 v[48:63], v[72:75], v[88:91], v[48:63]
    ds_read_b64_tr_b16 v[84:85], v106 offset:27776
    ds_read_b64_tr_b16 v[86:87], v106 offset:28544
    buffer_load_dwordx4 v98, s[8:11], s56 offen offset:2048 lds
    s_cmp_lg_u32 s7, 4
    s_cbranch_scc1 K1_NOCS20
    v_mfma_f32_4x4x4_16b_bf16 v[120:123], v[132:133], v[64:65], v[120:123]
    v_mfma_f32_4x4x4_16b_bf16 v[124:127], v[132:133], v[68:69], v[124:127]
    v_mfma_f32_4x4x4_16b_bf16 v[128:131], v[132:133], v[72:73], v[128:131]
    v_mfma_f32_4x4x4_16b_bf16 v[120:123], v[132:133], v[66:67], v[120:123]
    v_mfma_f32_4x4x4_16b_bf16 v[124:127], v[132:133], v[70:71], v[124:127]
    v_mfma_f32_4x4x4_16b_bf16 v[128:131], v[132:133], v[74:75], v[128:131]
K1_NOCS20:
    s_waitcnt lgkmcnt(4)
    v_mfma_f32_32x32x16_bf16 v[16:31], v[76:79], v[92:95], v[16:31]
    ds_read_b128 v[88:91], v104 offset:8192
    ds_read_b64_tr_b16 v[64:65], v106 offset:30720
    ds_read_b64_tr_b16 v[66:67], v106 offset:31488
    buffer_load_dwordx4 v99, s[8:11], s56 offen offset:3072 lds
    s_add_u32 s56, s56, 128
    s_and_b32 s56, s56, 1023
    s_add_u32 m0, s33, 12288
    s_waitcnt lgkmcnt(5)
    v_mfma_f32_32x32x16_bf16 v[32:47], v[80:83], v[92:95], v[32:47]
    ds_read_b64_tr_b16 v[68:69], v106 offset:30784
    ds_read_b64_tr_b16 v[70:71], v106 offset:31552
    s_waitcnt lgkmcnt(5)
    v_mfma_f32_32x32x16_bf16 v[48:63], v[84:87], v[92:95], v[48:63]
    ds_read_b64_tr_b16 v[72:73], v106 offset:30848
    ds_read_b64_tr_b16 v[74:75], v106 offset:31616
    s_mov_b64 exec, s[34:35]
    buffer_load_dwordx4 v100, s[12:15], s57 offen offset:0 lds
    s_mov_b64 exec, -1
    s_cmp_lg_u32 s7, 5
    s_cbranch_scc1 K1_NOCS21
    v_mfma_f32_4x4x4_16b_bf16 v[120:123], v[132:133], v[76:77], v[120:123]
    v_mfma_f32_4x4x4_16b_bf16 v[124:127], v[132:133], v[80:81], v[124:127]
    v_mfma_f32_4x4x4_16b_bf16 v[128:131], v[132:133], v[84:85], v[128:131]
    v_mfma_f32_4x4x4_16b_bf16 v[120:123], v[132:133], v[78:79], v[120:123]
    v_mfma_f32_4x4x4_16b_bf16 v[124:127], v[132:133], v[82:83], v[124:127]
    v_mfma_f32_4x4x4_16b_bf16 v[128:131], v[132:133], v[86:87], v[128:131]
K1_NOCS21:
    s_waitcnt lgkmcnt(4)
    v_mfma_f32_32x32x16_bf16 v[16:31], v[64:67], v[88:91], v[16:31]
    ds_read_b128 v[92:95], v105 offset:8192
    ds_read_b64_tr_b16 v[76:77], v106 offset:33792
    ds_read_b64_tr_b16 v[78:79], v106 offset:34560
    s_mov_b64 exec, s[34:35]
    buffer_load_dwordx4 v101, s[12:15], s57 offen offset:768 lds
    s_mov_b64 exec, -1
    s_add_u32 s57, s57, s39
    s_cmp_eq_u32 s57, s59
    s_cselect_b32 s57, 0, s57
    s_waitcnt lgkmcnt(5)
    v_mfma_f32_32x32x16_bf16 v[32:47], v[68:71], v[88:91], v[32:47]
    ds_read_b64_tr_b16 v[80:81], v106 offset:33856
    ds_read_b64_tr_b16 v[82:83], v106 offset:34624
    s_waitcnt lgkmcnt(5)
    v_mfma_f32_32x32x16_bf16 v[48:63], v[72:75], v[88:91], v[48:63]
    ds_read_b64_tr_b16 v[84:85], v106 offset:33920
    ds_read_b64_tr_b16 v[86:87], v106 offset:34688
    s_cmp_lg_u32 s7, 6
    s_cbranch_scc1 K1_NOCS22
    v_mfma_f32_4x4x4_16b_bf16 v[120:123], v[132:133], v[64:65], v[120:123]
    v_mfma_f32_4x4x4_16b_bf16 v[124:127], v[132:133], v[68:69], v[124:127]
    v_mfma_f32_4x4x4_16b_bf16 v[128:131], v[132:133], v[72:73], v[128:131]
    v_mfma_f32_4x4x4_16b_bf16 v[120:123], v[132:133], v[66:67], v[120:123]
    v_mfma_f32_4x4x4_16b_bf16 v[124:127], v[132:133], v[70:71], v[124:127]
    v_mfma_f32_4x4x4_16b_bf16 v[128:131], v[132:133], v[74:75], v[128:131]
K1_NOCS22:
    s_waitcnt lgkmcnt(4)
    v_mfma_f32_32x32x16_bf16 v[16:31], v[76:79], v[92:95], v[16:31]
    s_waitcnt vmcnt(6) lgkmcnt(0)
    s_barrier
    ds_read_b128 v[88:91], v102 offset:0
    ds_read_b64_tr_b16 v[64:65], v106 offset:0
    ds_read_b64_tr_b16 v[66:67], v106 offset:768
    buffer_load_dword v108, v233, s[24:27], 0 offen sc1
    v_mfma_f32_32x32x16_bf16 v[32:47], v[80:83], v[92:95], v[32:47]
    ds_read_b64_tr_b16 v[68:69], v106 offset:64
    ds_read_b64_tr_b16 v[70:71], v106 offset:832
    v_mfma_f32_32x32x16_bf16 v[48:63], v[84:87], v[92:95], v[48:63]
    ds_read_b64_tr_b16 v[72:73], v106 offset:128
    ds_read_b64_tr_b16 v[74:75], v106 offset:896
    s_cmp_lg_u32 s7, 7
    s_cbranch_scc1 K1_NOCS23
    v_mfma_f32_4x4x4_16b_bf16 v[120:123], v[132:133], v[76:77], v[120:123]
    v_mfma_f32_4x4x4_16b_bf16 v[124:127], v[132:133], v[80:81], v[124:127]
    v_mfma_f32_4x4x4_16b_bf16 v[128:131], v[132:133], v[84:85], v[128:131]
    v_mfma_f32_4x4x4_16b_bf16 v[120:123], v[132:133], v[78:79], v[120:123]
    v_mfma_f32_4x4x4_16b_bf16 v[124:127], v[132:133], v[82:83], v[124:127]
    v_mfma_f32_4x4x4_16b_bf16 v[128:131], v[132:133], v[86:87], v[128:131]
K1_NOCS23:
    s_waitcnt lgkmcnt(4)
    v_mfma_f32_32x32x16_bf16 v[16:31], v[64:67], v[88:91], v[16:31]
    ds_read_b128 v[92:95], v103 offset:0
    ds_read_b64_tr_b16 v[76:77], v106 offset:3072
    ds_read_b64_tr_b16 v[78:79], v106 offset:3840
    s_waitcnt lgkmcnt(5)
    v_mfma_f32_32x32x16_bf16 v[32:47], v[68:71], v[88:91], v[32:47]
    ds_read_b64_tr_b16 v[80:81], v106 offset:3136
    ds_read_b64_tr_b16 v[82:83], v106 offset:3904
    s_waitcnt lgkmcnt(5)
    v_mfma_f32_32x32x16_bf16 v[48:63], v[72:75], v[88:91], v[48:63]
    ds_read_b64_tr_b16 v[84:85], v106 offset:3200
    ds_read_b64_tr_b16 v[86:87], v106 offset:3968
    s_cmp_lg_u32 s7, 0
    s_cbranch_scc1 K1_NOCS24
    v_mfma_f32_4x4x4_16b_bf16 v[120:123], v[132:133], v[64:65], v[120:123]
    v_mfma_f32_4x4x4_16b_bf16 v[124:127], v[132:133], v[68:69], v[124:127]
    v_mfma_f32_4x4x4_16b_bf16 v[128:131], v[132:133], v[72:73], v[128:131]
    v_mfma_f32_4x4x4_16b_bf16 v[120:123], v[132:133], v[66:67], v[120:123]
    v_mfma_f32_4x4x4_16b_bf16 v[124:127], v[132:133], v[70:71], v[124:127]
    v_mfma_f32_4x4x4_16b_bf16 v[128:131], v[132:133], v[74:75], v[128:131]
K1_NOCS24:
    s_waitcnt lgkmcnt(4)
    v_mfma_f32_32x32x16_bf16 v[16:31], v[76:79], v[92:95], v[16:31]
    ds_read_b128 v[88:91], v104 offset:0
    ds_read_b64_tr_b16 v[64:65], v106 offset:6144
    ds_read_b64_tr_b16 v[66:67], v106 offset:6912
    s_waitcnt lgkmcnt(5)
    v_mfma_f32_32x32x16_bf16 v[32:47], v[80:83], v[92:95], v[32:47]
    ds_read_b64_tr_b16 v[68:69], v106 offset:6208
    ds_read_b64_tr_b16 v[70:71], v106 offset:6976
    s_waitcnt lgkmcnt(5)
    v_mfma_f32_32x32x16_bf16 v[48:63], v[84:87], v[92:95], v[48:63]
    ds_read_b64_tr_b16 v[72:73], v106 offset:6272
    ds_read_b64_tr_b16 v[74:75], v106 offset:7040
    s_cmp_lg_u32 s7, 1
    s_cbranch_scc1 K1_NOCS25
    v_mfma_f32_4x4x4_16b_bf16 v[120:123], v[132:133], v[76:77], v[120:123]
    v_mfma_f32_4x4x4_16b_bf16 v[124:127], v[132:133], v[80:81], v[124:127]
    v_mfma_f32_4x4x4_16b_bf16 v[128:131], v[132:133], v[84:85], v[128:131]
    v_mfma_f32_4x4x4_16b_bf16 v[120:123], v[132:133], v[78:79], v[120:123]
    v_mfma_f32_4x4x4_16b_bf16 v[124:127], v[132:133], v[82:83], v[124:127]
    v_mfma_f32_4x4x4_16b_bf16 v[128:131], v[132:133], v[86:87], v[128:131]
K1_NOCS25:
    s_waitcnt lgkmcnt(4)
    v_mfma_f32_32x32x16_bf16 v[16:31], v[64:67], v[88:91], v[16:31]
    ds_read_b128 v[92:95], v105 offset:0
    ds_read_b64_tr_b16 v[76:77], v106 offset:9216
    ds_read_b64_tr_b16 v[78:79], v106 offset:9984
    s_waitcnt lgkmcnt(5)
    v_mfma_f32_32x32x16_bf16 v[32:47], v[68:71], v[88:91], v[32:47]
    ds_read_b64_tr_b16 v[80:81], v106 offset:9280
    ds_read_b64_tr_b16 v[82:83], v106 offset:10048
    s_waitcnt lgkmcnt(5)
    v_mfma_f32_32x32x16_bf16 v[48:63], v[72:75], v[88:91], v[48:63]
    ds_read_b64_tr_b16 v[84:85], v106 offset:9344
    ds_read_b64_tr_b16 v[86:87], v106 offset:10112
    s_cmp_lg_u32 s7, 2
    s_cbranch_scc1 K1_NOCS26
    v_mfma_f32_4x4x4_16b_bf16 v[120:123], v[132:133], v[64:65], v[120:123]
    v_mfma_f32_4x4x4_16b_bf16 v[124:127], v[132:133], v[68:69], v[124:127]
    v_mfma_f32_4x4x4_16b_bf16 v[128:131], v[132:133], v[72:73], v[128:131]
    v_mfma_f32_4x4x4_16b_bf16 v[120:123], v[132:133], v[66:67], v[120:123]
    v_mfma_f32_4x4x4_16b_bf16 v[124:127], v[132:133], v[70:71], v[124:127]
    v_mfma_f32_4x4x4_16b_bf16 v[128:131], v[132:133], v[74:75], v[128:131]
K1_NOCS26:
    s_waitcnt lgkmcnt(4)
    v_mfma_f32_32x32x16_bf16 v[16:31], v[76:79], v[92:95], v[16:31]
    s_waitcnt vmcnt(0) lgkmcnt(0)
    v_cmp_eq_u32 vcc, s36, v108
    s_cmp_eq_u32 s7, 0
    s_cbranch_scc0 K1_SOK
    s_andn2_b32 s3, s61, vcc_lo
    s_cbranch_scc1 K1_SPOLL
K1_SOK:
    s_barrier
    ds_read_b128 v[88:91], v102 offset:4096
    ds_read_b64_tr_b16 v[64:65], v106 offset:12288
    ds_read_b64_tr_b16 v[66:67], v106 offset:13056
    v_mfma_f32_32x32x16_bf16 v[32:47], v[80:83], v[92:95], v[32:47]
    ds_read_b64_tr_b16 v[68:69], v106 offset:12352
    ds_read_b64_tr_b16 v[70:71], v106 offset:13120
    buffer_load_dwordx2 v[10:11], v9, s[24:27], 0 offen sc1
    s_and_b32 s3, s2, -8
    s_add_u32 s3, s3, s7
    s_cmp_lt_u32 s3, 172
    s_cselect_b32 s76, s88, s84
    s_cselect_b32 s77, s89, s85
    s_mov_b32 s78, 0x80000
    s_cselect_b32 s78, 0x158000, s78
    s_cselect_b32 s4, 0, 172
    s_mov_b32 s79, 0x00020000
    s_sub_u32 s3, s3, s4
    s_lshl_b32 s3, s3, 13
    v_lshl_add_u32 v237, v1, 7, s3
    buffer_load_dword v238, v237, s[76:79], 0 offen
    v_mfma_f32_32x32x16_bf16 v[48:63], v[84:87], v[92:95], v[48:63]
    ds_read_b64_tr_b16 v[72:73], v106 offset:12416
    ds_read_b64_tr_b16 v[74:75], v106 offset:13184
    s_cmp_lg_u32 s7, 3
    s_cbranch_scc1 K1_NOCS27
    v_mfma_f32_4x4x4_16b_bf16 v[120:123], v[132:133], v[76:77], v[120:123]
    v_mfma_f32_4x4x4_16b_bf16 v[124:127], v[132:133], v[80:81], v[124:127]
    v_mfma_f32_4x4x4_16b_bf16 v[128:131], v[132:133], v[84:85], v[128:131]
    v_mfma_f32_4x4x4_16b_bf16 v[120:123], v[132:133], v[78:79], v[120:123]
    v_mfma_f32_4x4x4_16b_bf16 v[124:127], v[132:133], v[82:83], v[124:127]
    v_mfma_f32_4x4x4_16b_bf16 v[128:131], v[132:133], v[86:87], v[128:131]
K1_NOCS27:
    s_waitcnt lgkmcnt(4)
    v_mfma_f32_32x32x16_bf16 v[16:31], v[64:67], v[88:91], v[16:31]
    ds_read_b128 v[92:95], v103 offset:4096
    ds_read_b64_tr_b16 v[76:77], v106 offset:15360
    ds_read_b64_tr_b16 v[78:79], v106 offset:16128
    s_waitcnt lgkmcnt(5)
    v_mfma_f32_32x32x16_bf16 v[32:47], v[68:71], v[88:91], v[32:47]
    ds_read_b64_tr_b16 v[80:81], v106 offset:15424
    ds_read_b64_tr_b16 v[82:83], v106 offset:16192
    s_waitcnt lgkmcnt(5)
    v_mfma_f32_32x32x16_bf16 v[48:63], v[72:75], v[88:91], v[48:63]
    ds_read_b64_tr_b16 v[84:85], v106 offset:15488
    ds_read_b64_tr_b16 v[86:87], v106 offset:16256
    s_cmp_lg_u32 s7, 4
    s_cbranch_scc1 K1_NOCS28
    v_mfma_f32_4x4x4_16b_bf16 v[120:123], v[132:133], v[64:65], v[120:123]
    v_mfma_f32_4x4x4_16b_bf16 v[124:127], v[132:133], v[68:69], v[124:127]
    v_mfma_f32_4x4x4_16b_bf16 v[128:131], v[132:133], v[72:73], v[128:131]
    v_mfma_f32_4x4x4_16b_bf16 v[120:123], v[132:133], v[66:67], v[120:123]
    v_mfma_f32_4x4x4_16b_bf16 v[124:127], v[132:133], v[70:71], v[124:127]
    v_mfma_f32_4x4x4_16b_bf16 v[128:131], v[132:133], v[74:75], v[128:131]
K1_NOCS28:
    s_waitcnt lgkmcnt(4)
    v_mfma_f32_32x32x16_bf16 v[16:31], v[76:79], v[92:95], v[16:31]
    ds_read_b128 v[88:91], v104 offset:4096
    ds_read_b64_tr_b16 v[64:65], v106 offset:18432
    ds_read_b64_tr_b16 v[66:67], v106 offset:19200
    s_waitcnt lgkmcnt(5)
    v_mfma_f32_32x32x16_bf16 v[32:47], v[80:83], v[92:95], v[32:47]
    ds_read_b64_tr_b16 v[68:69], v106 offset:18496
    ds_read_b64_tr_b16 v[70:71], v106 offset:19264
    s_waitcnt lgkmcnt(5)
    v_mfma_f32_32x32x16_bf16 v[48:63], v[84:87], v[92:95], v[48:63]
    ds_read_b64_tr_b16 v[72:73], v106 offset:18560
    ds_read_b64_tr_b16 v[74:75], v106 offset:19328
    s_cmp_lg_u32 s7, 5
    s_cbranch_scc1 K1_NOCS29
    v_mfma_f32_4x4x4_16b_bf16 v[120:123], v[132:133], v[76:77], v[120:123]
    v_mfma_f32_4x4x4_16b_bf16 v[124:127], v[132:133], v[80:81], v[124:127]
    v_mfma_f32_4x4x4_16b_bf16 v[128:131], v[132:133], v[84:85], v[128:131]
    v_mfma_f32_4x4x4_16b_bf16 v[120:123], v[132:133], v[78:79], v[120:123]
    v_mfma_f32_4x4x4_16b_bf16 v[124:127], v[132:133], v[82:83], v[124:127]
    v_mfma_f32_4x4x4_16b_bf16 v[128:131], v[132:133], v[86:87], v[128:131]
K1_NOCS29:
    s_waitcnt lgkmcnt(4)
    v_mfma_f32_32x32x16_bf16 v[16:31], v[64:67], v[88:91], v[16:31]
    ds_read_b128 v[92:95], v105 offset:4096
    ds_read_b64_tr_b16 v[76:77], v106 offset:21504
    ds_read_b64_tr_b16 v[78:79], v106 offset:22272
    s_waitcnt lgkmcnt(5)
    v_mfma_f32_32x32x16_bf16 v[32:47], v[68:71], v[88:91], v[32:47]
    ds_read_b64_tr_b16 v[80:81], v106 offset:21568
    ds_read_b64_tr_b16 v[82:83], v106 offset:22336
    s_waitcnt lgkmcnt(5)
    v_mfma_f32_32x32x16_bf16 v[48:63], v[72:75], v[88:91], v[48:63]
    ds_read_b64_tr_b16 v[84:85], v106 offset:21632
    ds_read_b64_tr_b16 v[86:87], v106 offset:22400
    s_cmp_lg_u32 s7, 6
    s_cbranch_scc1 K1_NOCS30
    v_mfma_f32_4x4x4_16b_bf16 v[120:123], v[132:133], v[64:65], v[120:123]
    v_mfma_f32_4x4x4_16b_bf16 v[124:127], v[132:133], v[68:69], v[124:127]
    v_mfma_f32_4x4x4_16b_bf16 v[128:131], v[132:133], v[72:73], v[128:131]
    v_mfma_f32_4x4x4_16b_bf16 v[120:123], v[132:133], v[66:67], v[120:123]
    v_mfma_f32_4x4x4_16b_bf16 v[124:127], v[132:133], v[70:71], v[124:127]
    v_mfma_f32_4x4x4_16b_bf16 v[128:131], v[132:133], v[74:75], v[128:131]
K1_NOCS30:
    s_waitcnt lgkmcnt(4)
    v_mfma_f32_32x32x16_bf16 v[16:31], v[76:79], v[92:95], v[16:31]
    s_waitcnt lgkmcnt(2)
    v_mfma_f32_32x32x16_bf16 v[32:47], v[80:83], v[92:95], v[32:47]
    s_waitcnt lgkmcnt(0)
    v_mfma_f32_32x32x16_bf16 v[48:63], v[84:87], v[92:95], v[48:63]
    s_cmp_lg_u32 s7, 7
    s_cbranch_scc1 K1_NOCS31
    v_mfma_f32_4x4x4_16b_bf16 v[120:123], v[132:133], v[76:77], v[120:123]
    v_mfma_f32_4x4x4_16b_bf16 v[124:127], v[132:133], v[80:81], v[124:127]
    v_mfma_f32_4x4x4_16b_bf16 v[128:131], v[132:133], v[84:85], v[128:131]
    v_mfma_f32_4x4x4_16b_bf16 v[120:123], v[132:133], v[78:79], v[120:123]
    v_mfma_f32_4x4x4_16b_bf16 v[124:127], v[132:133], v[82:83], v[124:127]
    v_mfma_f32_4x4x4_16b_bf16 v[128:131], v[132:133], v[86:87], v[128:131]
K1_NOCS31:
    v_lshlrev_b32 v3, 16, v112
    v_lshlrev_b32 v4, 2, v0
    s_cmp_lt_u32 s6, 16
    s_cselect_b32 s3, 0, 96
    v_cmp_gt_u32 vcc, s3, v0
    s_and_saveexec_b64 s[46:47], vcc
    v_add_u32 v4, 0x27800, v4
    ds_write_b32 v4, v3
    s_mov_b64 exec, -1
    v_and_b32 v3, 31, v1
    v_lshlrev_b32 v3, 2, v3
    s_mul_i32 s3, s7, 384
    s_add_u32 s4, s3, 155648
    v_add_u32 v3, s4, v3
    s_add_u32 s46, s3, 158720
    v_mov_b32 v121, v120
    v_mov_b32 v125, v124
    v_mov_b32 v129, v128
    s_nop 0
    v_permlane32_swap_b32 v121, v120
    v_permlane32_swap_b32 v125, v124
    v_permlane32_swap_b32 v129, v128
    s_nop 0
    v_add_f32 v120, v120, v121
    v_add_f32 v124, v124, v125
    v_add_f32 v128, v128, v129
    ds_write_b32 v3, v120 offset:0
    ds_write_b32 v3, v124 offset:128
    ds_write_b32 v3, v128 offset:256
    v_min_u32 v4, 47, v1
    v_lshlrev_b32 v4, 3, v4
    v_add_u32 v3, 0x26000, v4
    v_add_u32 v4, s46, v4
    s_waitcnt lgkmcnt(0)
    s_barrier
    ds_read_b64 v[64:65], v3 offset:0
    ds_read_b64 v[66:67], v3 offset:384
    ds_read_b64 v[68:69], v3 offset:768
    ds_read_b64 v[70:71], v3 offset:1152
    ds_read_b64 v[72:73], v3 offset:1536
    ds_read_b64 v[74:75], v3 offset:1920
    ds_read_b64 v[76:77], v3 offset:2304
    ds_read_b64 v[78:79], v3 offset:2688
    v_lshrrev_b32 v5, 5, v1
    v_lshlrev_b32 v5, 4, v5
    v_add_u32 v3, s46, v5
    v_add_u32 v5, 0x27800, v5
    s_lshl_b32 s3, s5, 3
    s_add_u32 s3, s3, s7
    s_lshl_b32 s3, s3, 10
    v_lshl_add_u32 v12, v1, 4, s3
    s_waitcnt lgkmcnt(6)
    v_pk_add_f32 v[64:65], v[64:65], v[66:67]
    s_waitcnt lgkmcnt(5)
    v_pk_add_f32 v[64:65], v[64:65], v[68:69]
    s_waitcnt lgkmcnt(4)
    v_pk_add_f32 v[64:65], v[64:65], v[70:71]
    s_waitcnt lgkmcnt(3)
    v_pk_add_f32 v[64:65], v[64:65], v[72:73]
    s_waitcnt lgkmcnt(2)
    v_pk_add_f32 v[64:65], v[64:65], v[74:75]
    s_waitcnt lgkmcnt(1)
    v_pk_add_f32 v[64:65], v[64:65], v[76:77]
    s_waitcnt lgkmcnt(0)
    v_pk_add_f32 v[64:65], v[64:65], v[78:79]
    ds_write_b64 v4, v[64:65]
    ds_read_b128 v[116:119], v3 offset:0
    ds_read_b128 v[120:123], v3 offset:32
    ds_read_b128 v[124:127], v3 offset:64
    ds_read_b128 v[128:131], v3 offset:96
    ds_read_b128 v[132:135], v3 offset:128
    ds_read_b128 v[136:139], v3 offset:160
    ds_read_b128 v[140:143], v3 offset:192
    ds_read_b128 v[144:147], v3 offset:224
    ds_read_b128 v[148:151], v3 offset:256
    ds_read_b128 v[152:155], v3 offset:288
    ds_read_b128 v[156:159], v3 offset:320
    ds_read_b128 v[160:163], v3 offset:352
    s_cmp_lt_u32 s6, 16
    s_cbranch_scc1 K1_QKV
    ds_read_b128 v[164:167], v5 offset:0
    ds_read_b128 v[168:171], v5 offset:32
    ds_read_b128 v[172:175], v5 offset:64
    ds_read_b128 v[176:179], v5 offset:96
    ds_read_b128 v[180:183], v5 offset:128
    ds_read_b128 v[184:187], v5 offset:160
    ds_read_b128 v[188:191], v5 offset:192
    ds_read_b128 v[192:195], v5 offset:224
    ds_read_b128 v[196:199], v5 offset:256
    ds_read_b128 v[200:203], v5 offset:288
    ds_read_b128 v[204:207], v5 offset:320
    ds_read_b128 v[208:211], v5 offset:352
    s_waitcnt vmcnt(1)
    s_mov_b32 s40, 0xbdd2d3e8
    s_mov_b32 s42, 0xc0135761
    v_mov_b32 v14, s42
    s_mul_i32 s3, s38, 6
    s_add_u32 s3, s3, 32
    s_lshl_b32 s44, s3, 16
    s_lshr_b32 s92, s2, 6
    s_and_b32 s3, s2, 7
    s_lshl_b32 s3, s3, 2
    s_add_u32 s92, s92, s3
    s_bfe_u32 s93, s2, 0x30003
    s_mul_i32 s94, s7, 12288
    s_add_u32 s94, s94, 57344
    v_lshrrev_b32 v3, 3, v1
    v_lshl_add_u32 v3, v2, 4, v3
    v_lshlrev_b32 v3, 10, v3
    v_bfe_u32 v4, v1, 4, 1
    v_lshlrev_b32 v4, 2, v4
    v_and_b32 v5, 7, v1
    v_xor_b32 v4, v4, v5
    v_lshlrev_b32 v4, 4, v4
    s_lshl_b32 s3, s93, 7
    v_add3_u32 v229, v3, v4, s3
    v_add_u32 v230, 7168, v229
    s_mov_b32 s12, s84
    s_mov_b32 s13, s85
    s_mov_b32 s14, 0x80000
    s_mov_b32 s15, 0x00020000
    s_mov_b32 s16, s88
    s_mov_b32 s17, s89
    s_mov_b32 s18, 0x158000
    s_mov_b32 s19, 0x00020000
    v_lshlrev_b32 v3, 4, v1
    v_lshlrev_b32 v4, 16, v2
    s_lshl_b32 s3, s92, 11
    v_add3_u32 v228, v3, v4, s3
    v_lshrrev_b32 v3, 5, v1
    v_bfe_u32 v4, v1, 2, 2
    v_lshl_add_u32 v3, v3, 2, v4
    v_lshlrev_b32 v3, 7, v3
    v_bfe_u32 v4, v1, 4, 1
    v_bfe_u32 v5, v1, 1, 1
    v_lshl_add_u32 v4, v4, 1, v5
    v_bfe_u32 v5, v1, 3, 1
    v_lshl_add_u32 v4, v5, 2, v4
    v_and_b32 v5, 1, v1
    v_lshlrev_b32 v5, 3, v5
    v_lshl_add_u32 v4, v4, 4, v5
    v_add3_u32 v231, v3, v4, s94
    v_xor_b32 v232, 64, v231
    s_waitcnt lgkmcnt(8)
    v_pk_fma_f32 v[164:165], v[116:117], v[10:11], v[164:165] op_sel:[0,1,0] op_sel_hi:[1,1,1]
    v_pk_fma_f32 v[166:167], v[118:119], v[10:11], v[166:167] op_sel:[0,1,0] op_sel_hi:[1,1,1]
    v_pk_fma_f32 v[168:169], v[120:121], v[10:11], v[168:169] op_sel:[0,1,0] op_sel_hi:[1,1,1]
    v_pk_fma_f32 v[170:171], v[122:123], v[10:11], v[170:171] op_sel:[0,1,0] op_sel_hi:[1,1,1]
    v_pk_fma_f32 v[172:173], v[124:125], v[10:11], v[172:173] op_sel:[0,1,0] op_sel_hi:[1,1,1]
    v_pk_fma_f32 v[174:175], v[126:127], v[10:11], v[174:175] op_sel:[0,1,0] op_sel_hi:[1,1,1]
    v_pk_fma_f32 v[176:177], v[128:129], v[10:11], v[176:177] op_sel:[0,1,0] op_sel_hi:[1,1,1]
    v_pk_fma_f32 v[178:179], v[130:131], v[10:11], v[178:179] op_sel:[0,1,0] op_sel_hi:[1,1,1]
    v_pk_fma_f32 v[16:17], v[16:17], v[10:11], v[164:165] op_sel_hi:[1,0,1]
    v_pk_fma_f32 v[18:19], v[18:19], v[10:11], v[166:167] op_sel_hi:[1,0,1]
    v_pk_fma_f32 v[20:21], v[20:21], v[10:11], v[168:169] op_sel_hi:[1,0,1]
    v_pk_fma_f32 v[22:23], v[22:23], v[10:11], v[170:171] op_sel_hi:[1,0,1]
    v_pk_fma_f32 v[24:25], v[24:25], v[10:11], v[172:173] op_sel_hi:[1,0,1]
    v_pk_fma_f32 v[26:27], v[26:27], v[10:11], v[174:175] op_sel_hi:[1,0,1]
    v_pk_fma_f32 v[28:29], v[28:29], v[10:11], v[176:177] op_sel_hi:[1,0,1]
    v_pk_fma_f32 v[30:31], v[30:31], v[10:11], v[178:179] op_sel_hi:[1,0,1]
    v_pk_mul_f32 v[64:65], v[16:17], v[16:17]
    v_pk_mul_f32 v[66:67], v[18:19], v[18:19]
    v_pk_mul_f32 v[68:69], v[20:21], v[20:21]
    v_pk_mul_f32 v[70:71], v[22:23], v[22:23]
    v_pk_mul_f32 v[72:73], v[24:25], v[24:25]
    v_pk_mul_f32 v[74:75], v[26:27], v[26:27]
    v_pk_mul_f32 v[76:77], v[28:29], v[28:29]
    v_pk_mul_f32 v[78:79], v[30:31], v[30:31]
    v_pk_fma_f32 v[64:65], v[64:65], s[40:41], v[14:15] op_sel_hi:[1,0,0]
    v_pk_fma_f32 v[66:67], v[66:67], s[40:41], v[14:15] op_sel_hi:[1,0,0]
    v_pk_fma_f32 v[68:69], v[68:69], s[40:41], v[14:15] op_sel_hi:[1,0,0]
    v_pk_fma_f32 v[70:71], v[70:71], s[40:41], v[14:15] op_sel_hi:[1,0,0]
    v_pk_fma_f32 v[72:73], v[72:73], s[40:41], v[14:15] op_sel_hi:[1,0,0]
    v_pk_fma_f32 v[74:75], v[74:75], s[40:41], v[14:15] op_sel_hi:[1,0,0]
    v_pk_fma_f32 v[76:77], v[76:77], s[40:41], v[14:15] op_sel_hi:[1,0,0]
    v_pk_fma_f32 v[78:79], v[78:79], s[40:41], v[14:15] op_sel_hi:[1,0,0]
    v_pk_mul_f32 v[64:65], v[64:65], v[16:17]
    v_pk_mul_f32 v[66:67], v[66:67], v[18:19]
    v_pk_mul_f32 v[68:69], v[68:69], v[20:21]
    v_pk_mul_f32 v[70:71], v[70:71], v[22:23]
    v_pk_mul_f32 v[72:73], v[72:73], v[24:25]
    v_pk_mul_f32 v[74:75], v[74:75], v[26:27]
    v_pk_mul_f32 v[76:77], v[76:77], v[28:29]
    v_pk_mul_f32 v[78:79], v[78:79], v[30:31]
    v_exp_f32 v64, v64
    v_exp_f32 v65, v65
    v_exp_f32 v66, v66
    v_exp_f32 v67, v67
    s_add_u32 m0, s94, 0
    s_mov_b32 s95, 0x0
    buffer_load_dwordx4 v229, s[16:19], s95 offen lds
    buffer_load_dwordx4 v230, s[16:19], s95 offen offset:1024 lds
    v_exp_f32 v68, v68
    v_exp_f32 v69, v69
    v_exp_f32 v70, v70
    v_exp_f32 v71, v71
    v_exp_f32 v72, v72
    v_exp_f32 v73, v73
    v_exp_f32 v74, v74
    v_exp_f32 v75, v75
    s_add_u32 m0, s94, 2048
    s_mov_b32 s95, 0x20000
    buffer_load_dwordx4 v229, s[16:19], s95 offen lds
    buffer_load_dwordx4 v230, s[16:19], s95 offen offset:1024 lds
    v_exp_f32 v76, v76
    v_exp_f32 v77, v77
    v_exp_f32 v78, v78
    v_exp_f32 v79, v79
    v_pk_add_f32 v[64:65], v[64:65], 1.0 op_sel_hi:[1,0]
    v_pk_add_f32 v[66:67], v[66:67], 1.0 op_sel_hi:[1,0]
    v_pk_add_f32 v[68:69], v[68:69], 1.0 op_sel_hi:[1,0]
    v_pk_add_f32 v[70:71], v[70:71], 1.0 op_sel_hi:[1,0]
    v_pk_add_f32 v[72:73], v[72:73], 1.0 op_sel_hi:[1,0]
    v_pk_add_f32 v[74:75], v[74:75], 1.0 op_sel_hi:[1,0]
    v_pk_add_f32 v[76:77], v[76:77], 1.0 op_sel_hi:[1,0]
    v_pk_add_f32 v[78:79], v[78:79], 1.0 op_sel_hi:[1,0]
    v_rcp_f32 v64, v64
    v_rcp_f32 v65, v65
    v_rcp_f32 v66, v66
    v_rcp_f32 v67, v67
    v_rcp_f32 v68, v68
    v_rcp_f32 v69, v69
    v_rcp_f32 v70, v70
    v_rcp_f32 v71, v71
    v_rcp_f32 v72, v72
    v_rcp_f32 v73, v73
    v_rcp_f32 v74, v74
    v_rcp_f32 v75, v75
    v_rcp_f32 v76, v76
    v_rcp_f32 v77, v77
    v_rcp_f32 v78, v78
    v_rcp_f32 v79, v79
    v_pk_mul_f32 v[16:17], v[64:65], v[16:17]
    v_pk_mul_f32 v[18:19], v[66:67], v[18:19]
    v_pk_mul_f32 v[20:21], v[68:69], v[20:21]
    v_pk_mul_f32 v[22:23], v[70:71], v[22:23]
    v_pk_mul_f32 v[24:25], v[72:73], v[24:25]
    v_pk_mul_f32 v[26:27], v[74:75], v[26:27]
    v_pk_mul_f32 v[28:29], v[76:77], v[28:29]
    v_pk_mul_f32 v[30:31], v[78:79], v[30:31]
    v_cvt_pk_bf16_f32 v80, v16, v17
    v_cvt_pk_bf16_f32 v81, v18, v19
    v_cvt_pk_bf16_f32 v82, v20, v21
    v_cvt_pk_bf16_f32 v83, v22, v23
    v_cvt_pk_bf16_f32 v84, v24, v25
    v_cvt_pk_bf16_f32 v85, v26, v27
    v_cvt_pk_bf16_f32 v86, v28, v29
    v_cvt_pk_bf16_f32 v87, v30, v31
    buffer_store_dwordx4 v[80:83], v12, s[20:23], s44 offen sc1
    s_add_u32 s44, s44, 0x10000
    buffer_store_dwordx4 v[84:87], v12, s[20:23], s44 offen sc1
    s_add_u32 s44, s44, 0x10000
    s_waitcnt lgkmcnt(4)
    v_pk_fma_f32 v[180:181], v[132:133], v[10:11], v[180:181] op_sel:[0,1,0] op_sel_hi:[1,1,1]
    v_pk_fma_f32 v[182:183], v[134:135], v[10:11], v[182:183] op_sel:[0,1,0] op_sel_hi:[1,1,1]
    v_pk_fma_f32 v[184:185], v[136:137], v[10:11], v[184:185] op_sel:[0,1,0] op_sel_hi:[1,1,1]
    v_pk_fma_f32 v[186:187], v[138:139], v[10:11], v[186:187] op_sel:[0,1,0] op_sel_hi:[1,1,1]
    v_pk_fma_f32 v[188:189], v[140:141], v[10:11], v[188:189] op_sel:[0,1,0] op_sel_hi:[1,1,1]
    v_pk_fma_f32 v[190:191], v[142:143], v[10:11], v[190:191] op_sel:[0,1,0] op_sel_hi:[1,1,1]
    v_pk_fma_f32 v[192:193], v[144:145], v[10:11], v[192:193] op_sel:[0,1,0] op_sel_hi:[1,1,1]
    v_pk_fma_f32 v[194:195], v[146:147], v[10:11], v[194:195] op_sel:[0,1,0] op_sel_hi:[1,1,1]
    v_pk_fma_f32 v[32:33], v[32:33], v[10:11], v[180:181] op_sel_hi:[1,0,1]
    v_pk_fma_f32 v[34:35], v[34:35], v[10:11], v[182:183] op_sel_hi:[1,0,1]
    v_pk_fma_f32 v[36:37], v[36:37], v[10:11], v[184:185] op_sel_hi:[1,0,1]
    v_pk_fma_f32 v[38:39], v[38:39], v[10:11], v[186:187] op_sel_hi:[1,0,1]
    v_pk_fma_f32 v[40:41], v[40:41], v[10:11], v[188:189] op_sel_hi:[1,0,1]
    v_pk_fma_f32 v[42:43], v[42:43], v[10:11], v[190:191] op_sel_hi:[1,0,1]
    v_pk_fma_f32 v[44:45], v[44:45], v[10:11], v[192:193] op_sel_hi:[1,0,1]
    v_pk_fma_f32 v[46:47], v[46:47], v[10:11], v[194:195] op_sel_hi:[1,0,1]
    v_pk_mul_f32 v[64:65], v[32:33], v[32:33]
    v_pk_mul_f32 v[66:67], v[34:35], v[34:35]
    v_pk_mul_f32 v[68:69], v[36:37], v[36:37]
    v_pk_mul_f32 v[70:71], v[38:39], v[38:39]
    v_pk_mul_f32 v[72:73], v[40:41], v[40:41]
    v_pk_mul_f32 v[74:75], v[42:43], v[42:43]
    v_pk_mul_f32 v[76:77], v[44:45], v[44:45]
    v_pk_mul_f32 v[78:79], v[46:47], v[46:47]
    v_pk_fma_f32 v[64:65], v[64:65], s[40:41], v[14:15] op_sel_hi:[1,0,0]
    v_pk_fma_f32 v[66:67], v[66:67], s[40:41], v[14:15] op_sel_hi:[1,0,0]
    v_pk_fma_f32 v[68:69], v[68:69], s[40:41], v[14:15] op_sel_hi:[1,0,0]
    v_pk_fma_f32 v[70:71], v[70:71], s[40:41], v[14:15] op_sel_hi:[1,0,0]
    v_pk_fma_f32 v[72:73], v[72:73], s[40:41], v[14:15] op_sel_hi:[1,0,0]
    v_pk_fma_f32 v[74:75], v[74:75], s[40:41], v[14:15] op_sel_hi:[1,0,0]
    v_pk_fma_f32 v[76:77], v[76:77], s[40:41], v[14:15] op_sel_hi:[1,0,0]
    v_pk_fma_f32 v[78:79], v[78:79], s[40:41], v[14:15] op_sel_hi:[1,0,0]
    v_pk_mul_f32 v[64:65], v[64:65], v[32:33]
    v_pk_mul_f32 v[66:67], v[66:67], v[34:35]
    v_pk_mul_f32 v[68:69], v[68:69], v[36:37]
    v_pk_mul_f32 v[70:71], v[70:71], v[38:39]
    v_pk_mul_f32 v[72:73], v[72:73], v[40:41]
    v_pk_mul_f32 v[74:75], v[74:75], v[42:43]
    v_pk_mul_f32 v[76:77], v[76:77], v[44:45]
    v_pk_mul_f32 v[78:79], v[78:79], v[46:47]
    v_exp_f32 v64, v64
    v_exp_f32 v65, v65
    v_exp_f32 v66, v66
    v_exp_f32 v67, v67
    s_add_u32 m0, s94, 4096
    s_mov_b32 s95, 0x40000
    buffer_load_dwordx4 v229, s[16:19], s95 offen lds
    buffer_load_dwordx4 v230, s[16:19], s95 offen offset:1024 lds
    v_exp_f32 v68, v68
    v_exp_f32 v69, v69
    v_exp_f32 v70, v70
    v_exp_f32 v71, v71
    v_exp_f32 v72, v72
    v_exp_f32 v73, v73
    v_exp_f32 v74, v74
    v_exp_f32 v75, v75
    s_add_u32 m0, s94, 6144
    s_mov_b32 s95, 0x60000
    buffer_load_dwordx4 v229, s[16:19], s95 offen lds
    buffer_load_dwordx4 v230, s[16:19], s95 offen offset:1024 lds
    v_exp_f32 v76, v76
    v_exp_f32 v77, v77
    v_exp_f32 v78, v78
    v_exp_f32 v79, v79
    v_pk_add_f32 v[64:65], v[64:65], 1.0 op_sel_hi:[1,0]
    v_pk_add_f32 v[66:67], v[66:67], 1.0 op_sel_hi:[1,0]
    v_pk_add_f32 v[68:69], v[68:69], 1.0 op_sel_hi:[1,0]
    v_pk_add_f32 v[70:71], v[70:71], 1.0 op_sel_hi:[1,0]
    v_pk_add_f32 v[72:73], v[72:73], 1.0 op_sel_hi:[1,0]
    v_pk_add_f32 v[74:75], v[74:75], 1.0 op_sel_hi:[1,0]
    v_pk_add_f32 v[76:77], v[76:77], 1.0 op_sel_hi:[1,0]
    v_pk_add_f32 v[78:79], v[78:79], 1.0 op_sel_hi:[1,0]
    v_rcp_f32 v64, v64
    v_rcp_f32 v65, v65
    v_rcp_f32 v66, v66
    v_rcp_f32 v67, v67
    v_rcp_f32 v68, v68
    v_rcp_f32 v69, v69
    v_rcp_f32 v70, v70
    v_rcp_f32 v71, v71
    v_rcp_f32 v72, v72
    v_rcp_f32 v73, v73
    v_rcp_f32 v74, v74
    v_rcp_f32 v75, v75
    v_rcp_f32 v76, v76
    v_rcp_f32 v77, v77
    v_rcp_f32 v78, v78
    v_rcp_f32 v79, v79
    v_pk_mul_f32 v[32:33], v[64:65], v[32:33]
    v_pk_mul_f32 v[34:35], v[66:67], v[34:35]
    v_pk_mul_f32 v[36:37], v[68:69], v[36:37]
    v_pk_mul_f32 v[38:39], v[70:71], v[38:39]
    v_pk_mul_f32 v[40:41], v[72:73], v[40:41]
    v_pk_mul_f32 v[42:43], v[74:75], v[42:43]
    v_pk_mul_f32 v[44:45], v[76:77], v[44:45]
    v_pk_mul_f32 v[46:47], v[78:79], v[46:47]
    v_cvt_pk_bf16_f32 v88, v32, v33
    v_cvt_pk_bf16_f32 v89, v34, v35
    v_cvt_pk_bf16_f32 v90, v36, v37
    v_cvt_pk_bf16_f32 v91, v38, v39
    v_cvt_pk_bf16_f32 v92, v40, v41
    v_cvt_pk_bf16_f32 v93, v42, v43
    v_cvt_pk_bf16_f32 v94, v44, v45
    v_cvt_pk_bf16_f32 v95, v46, v47
    buffer_store_dwordx4 v[88:91], v12, s[20:23], s44 offen sc1
    s_add_u32 s44, s44, 0x10000
    buffer_store_dwordx4 v[92:95], v12, s[20:23], s44 offen sc1
    s_add_u32 s44, s44, 0x10000
    s_waitcnt lgkmcnt(0)
    v_pk_fma_f32 v[196:197], v[148:149], v[10:11], v[196:197] op_sel:[0,1,0] op_sel_hi:[1,1,1]
    v_pk_fma_f32 v[198:199], v[150:151], v[10:11], v[198:199] op_sel:[0,1,0] op_sel_hi:[1,1,1]
    v_pk_fma_f32 v[200:201], v[152:153], v[10:11], v[200:201] op_sel:[0,1,0] op_sel_hi:[1,1,1]
    v_pk_fma_f32 v[202:203], v[154:155], v[10:11], v[202:203] op_sel:[0,1,0] op_sel_hi:[1,1,1]
    v_pk_fma_f32 v[204:205], v[156:157], v[10:11], v[204:205] op_sel:[0,1,0] op_sel_hi:[1,1,1]
    v_pk_fma_f32 v[206:207], v[158:159], v[10:11], v[206:207] op_sel:[0,1,0] op_sel_hi:[1,1,1]
    v_pk_fma_f32 v[208:209], v[160:161], v[10:11], v[208:209] op_sel:[0,1,0] op_sel_hi:[1,1,1]
    v_pk_fma_f32 v[210:211], v[162:163], v[10:11], v[210:211] op_sel:[0,1,0] op_sel_hi:[1,1,1]
    v_pk_fma_f32 v[48:49], v[48:49], v[10:11], v[196:197] op_sel_hi:[1,0,1]
    v_pk_fma_f32 v[50:51], v[50:51], v[10:11], v[198:199] op_sel_hi:[1,0,1]
    v_pk_fma_f32 v[52:53], v[52:53], v[10:11], v[200:201] op_sel_hi:[1,0,1]
    v_pk_fma_f32 v[54:55], v[54:55], v[10:11], v[202:203] op_sel_hi:[1,0,1]
    v_pk_fma_f32 v[56:57], v[56:57], v[10:11], v[204:205] op_sel_hi:[1,0,1]
    v_pk_fma_f32 v[58:59], v[58:59], v[10:11], v[206:207] op_sel_hi:[1,0,1]
    v_pk_fma_f32 v[60:61], v[60:61], v[10:11], v[208:209] op_sel_hi:[1,0,1]
    v_pk_fma_f32 v[62:63], v[62:63], v[10:11], v[210:211] op_sel_hi:[1,0,1]
    v_pk_mul_f32 v[64:65], v[48:49], v[48:49]
    v_pk_mul_f32 v[66:67], v[50:51], v[50:51]
    v_pk_mul_f32 v[68:69], v[52:53], v[52:53]
    v_pk_mul_f32 v[70:71], v[54:55], v[54:55]
    v_pk_mul_f32 v[72:73], v[56:57], v[56:57]
    v_pk_mul_f32 v[74:75], v[58:59], v[58:59]
    v_pk_mul_f32 v[76:77], v[60:61], v[60:61]
    v_pk_mul_f32 v[78:79], v[62:63], v[62:63]
    v_pk_fma_f32 v[64:65], v[64:65], s[40:41], v[14:15] op_sel_hi:[1,0,0]
    v_pk_fma_f32 v[66:67], v[66:67], s[40:41], v[14:15] op_sel_hi:[1,0,0]
    v_pk_fma_f32 v[68:69], v[68:69], s[40:41], v[14:15] op_sel_hi:[1,0,0]
    v_pk_fma_f32 v[70:71], v[70:71], s[40:41], v[14:15] op_sel_hi:[1,0,0]
    v_pk_fma_f32 v[72:73], v[72:73], s[40:41], v[14:15] op_sel_hi:[1,0,0]
    v_pk_fma_f32 v[74:75], v[74:75], s[40:41], v[14:15] op_sel_hi:[1,0,0]
    v_pk_fma_f32 v[76:77], v[76:77], s[40:41], v[14:15] op_sel_hi:[1,0,0]
    v_pk_fma_f32 v[78:79], v[78:79], s[40:41], v[14:15] op_sel_hi:[1,0,0]
    v_pk_mul_f32 v[64:65], v[64:65], v[48:49]
    v_pk_mul_f32 v[66:67], v[66:67], v[50:51]
    v_pk_mul_f32 v[68:69], v[68:69], v[52:53]
    v_pk_mul_f32 v[70:71], v[70:71], v[54:55]
    v_pk_mul_f32 v[72:73], v[72:73], v[56:57]
    v_pk_mul_f32 v[74:75], v[74:75], v[58:59]
    v_pk_mul_f32 v[76:77], v[76:77], v[60:61]
    v_pk_mul_f32 v[78:79], v[78:79], v[62:63]
    v_exp_f32 v64, v64
    v_exp_f32 v65, v65
    v_exp_f32 v66, v66
    v_exp_f32 v67, v67
    s_add_u32 m0, s94, 8192
    s_mov_b32 s95, 0x80000
    buffer_load_dwordx4 v229, s[16:19], s95 offen lds
    buffer_load_dwordx4 v230, s[16:19], s95 offen offset:1024 lds
    v_exp_f32 v68, v68
    v_exp_f32 v69, v69
    v_exp_f32 v70, v70
    v_exp_f32 v71, v71
    v_exp_f32 v72, v72
    v_exp_f32 v73, v73
    v_exp_f32 v74, v74
    v_exp_f32 v75, v75
    s_add_u32 m0, s94, 10240
    s_mov_b32 s95, 0xa0000
    buffer_load_dwordx4 v229, s[16:19], s95 offen lds
    buffer_load_dwordx4 v230, s[16:19], s95 offen offset:1024 lds
    v_exp_f32 v76, v76
    v_exp_f32 v77, v77
    v_exp_f32 v78, v78
    v_exp_f32 v79, v79
    v_pk_add_f32 v[64:65], v[64:65], 1.0 op_sel_hi:[1,0]
    v_pk_add_f32 v[66:67], v[66:67], 1.0 op_sel_hi:[1,0]
    v_pk_add_f32 v[68:69], v[68:69], 1.0 op_sel_hi:[1,0]
    v_pk_add_f32 v[70:71], v[70:71], 1.0 op_sel_hi:[1,0]
    v_pk_add_f32 v[72:73], v[72:73], 1.0 op_sel_hi:[1,0]
    v_pk_add_f32 v[74:75], v[74:75], 1.0 op_sel_hi:[1,0]
    v_pk_add_f32 v[76:77], v[76:77], 1.0 op_sel_hi:[1,0]
    v_pk_add_f32 v[78:79], v[78:79], 1.0 op_sel_hi:[1,0]
    v_rcp_f32 v64, v64
    v_rcp_f32 v65, v65
    v_rcp_f32 v66, v66
    v_rcp_f32 v67, v67
    v_rcp_f32 v68, v68
    v_rcp_f32 v69, v69
    v_rcp_f32 v70, v70
    v_rcp_f32 v71, v71
    v_rcp_f32 v72, v72
    v_rcp_f32 v73, v73
    v_rcp_f32 v74, v74
    v_rcp_f32 v75, v75
    v_rcp_f32 v76, v76
    v_rcp_f32 v77, v77
    v_rcp_f32 v78, v78
    v_rcp_f32 v79, v79
    v_pk_mul_f32 v[48:49], v[64:65], v[48:49]
    v_pk_mul_f32 v[50:51], v[66:67], v[50:51]
    v_pk_mul_f32 v[52:53], v[68:69], v[52:53]
    v_pk_mul_f32 v[54:55], v[70:71], v[54:55]
    v_pk_mul_f32 v[56:57], v[72:73], v[56:57]
    v_pk_mul_f32 v[58:59], v[74:75], v[58:59]
    v_pk_mul_f32 v[60:61], v[76:77], v[60:61]
    v_pk_mul_f32 v[62:63], v[78:79], v[62:63]
    v_cvt_pk_bf16_f32 v80, v48, v49
    v_cvt_pk_bf16_f32 v81, v50, v51
    v_cvt_pk_bf16_f32 v82, v52, v53
    v_cvt_pk_bf16_f32 v83, v54, v55
    v_cvt_pk_bf16_f32 v84, v56, v57
    v_cvt_pk_bf16_f32 v85, v58, v59
    v_cvt_pk_bf16_f32 v86, v60, v61
    v_cvt_pk_bf16_f32 v87, v62, v63
    buffer_store_dwordx4 v[80:83], v12, s[20:23], s44 offen sc1
    s_add_u32 s44, s44, 0x10000
    buffer_store_dwordx4 v[84:87], v12, s[20:23], s44 offen sc1
    s_add_u32 s44, s44, 0x10000
    s_waitcnt vmcnt(0)
    s_barrier
    s_cmp_eq_u32 s7, 0
    s_cbranch_scc0 K1_HOK
    v_mov_b32 v3, s36
    buffer_store_dword v3, v234, s[24:27], 0 offen sc1
K1_HPOLL:
    s_cmp_eq_u32 s7, 0
    s_cbranch_scc0 K1_HOK
    s_mov_b32 s4, 0
K1_HP2:
    buffer_load_dword v3, v233, s[24:27], 0 offen sc1
    s_add_u32 s4, s4, 1
    s_waitcnt vmcnt(0)
    v_cmp_eq_u32 vcc, s36, v3
    s_cmp_lt_u32 s4, 0x40000
    s_cbranch_scc0 K1_HOK
    s_andn2_b32 s3, 2147418112, vcc_hi
    s_cbranch_scc0 K1_HOK
    s_movk_i32 s3, 20
K1_HP2D:
    s_sub_u32 s3, s3, 1
    s_cbranch_scc0 K1_HP2D
    s_branch K1_HP2
K1_HOK:
    s_barrier
    s_branch K1_FIN
K1_QKV:
    v_bfe_u32 v3, v1, 4, 1
    v_lshrrev_b32 v4, 5, v1
    v_lshl_add_u32 v3, v3, 2, v4
    v_bfe_u32 v4, v1, 2, 2
    v_lshl_add_u32 v3, v3, 2, v4
    v_and_b32 v4, 3, v1
    v_lshl_add_u32 v3, v3, 2, v4
    v_lshlrev_b32 v3, 3, v3
    v_add_u32 v3, 0x27800, v3
    ds_read_b64_tr_b16 v[112:113], v3
    ds_read_b64_tr_b16 v[114:115], v3 offset:256
    v_and_b32 v3, 31, v1
    v_lshl_add_u32 v3, v2, 5, v3
    v_mul_u32_u24 v13, 200, v3
    v_lshrrev_b32 v3, 5, v1
    v_lshl_add_u32 v13, v3, 3, v13
    s_waitcnt vmcnt(1) lgkmcnt(6)
    v_pk_mul_f32 v[132:133], v[132:133], v[10:11] op_sel:[0,1] op_sel_hi:[1,1]
    v_pk_mul_f32 v[134:135], v[134:135], v[10:11] op_sel:[0,1] op_sel_hi:[1,1]
    v_pk_mul_f32 v[136:137], v[136:137], v[10:11] op_sel:[0,1] op_sel_hi:[1,1]
    v_pk_mul_f32 v[138:139], v[138:139], v[10:11] op_sel:[0,1] op_sel_hi:[1,1]
    v_pk_mul_f32 v[140:141], v[140:141], v[10:11] op_sel:[0,1] op_sel_hi:[1,1]
    v_pk_mul_f32 v[142:143], v[142:143], v[10:11] op_sel:[0,1] op_sel_hi:[1,1]
    v_pk_mul_f32 v[144:145], v[144:145], v[10:11] op_sel:[0,1] op_sel_hi:[1,1]
    v_pk_mul_f32 v[146:147], v[146:147], v[10:11] op_sel:[0,1] op_sel_hi:[1,1]
    v_pk_fma_f32 v[32:33], v[32:33], v[10:11], v[132:133] op_sel_hi:[1,0,1]
    v_pk_fma_f32 v[34:35], v[34:35], v[10:11], v[134:135] op_sel_hi:[1,0,1]
    v_pk_fma_f32 v[36:37], v[36:37], v[10:11], v[136:137] op_sel_hi:[1,0,1]
    v_pk_fma_f32 v[38:39], v[38:39], v[10:11], v[138:139] op_sel_hi:[1,0,1]
    v_pk_fma_f32 v[40:41], v[40:41], v[10:11], v[140:141] op_sel_hi:[1,0,1]
    v_pk_fma_f32 v[42:43], v[42:43], v[10:11], v[142:143] op_sel_hi:[1,0,1]
    v_pk_fma_f32 v[44:45], v[44:45], v[10:11], v[144:145] op_sel_hi:[1,0,1]
    v_pk_fma_f32 v[46:47], v[46:47], v[10:11], v[146:147] op_sel_hi:[1,0,1]
    v_cvt_pk_bf16_f32 v72, v32, v33
    v_cvt_pk_bf16_f32 v73, v34, v35
    v_cvt_pk_bf16_f32 v74, v36, v37
    v_cvt_pk_bf16_f32 v75, v38, v39
    v_cvt_pk_bf16_f32 v76, v40, v41
    v_cvt_pk_bf16_f32 v77, v42, v43
    v_cvt_pk_bf16_f32 v78, v44, v45
    v_cvt_pk_bf16_f32 v79, v46, v47
    s_waitcnt lgkmcnt(0)
    v_and_b32 v3, 16, v1
    v_cmp_eq_u32 vcc, 0, v3
    s_mov_b32 s40, 0x3fb8aa3b
    s_nop 0
    v_cndmask_b32 v64, 0, v112, vcc
    v_cndmask_b32_e64 v68, v112, 0, vcc
    v_cndmask_b32 v65, 0, v113, vcc
    v_cndmask_b32_e64 v69, v113, 0, vcc
    v_cndmask_b32 v66, 0, v114, vcc
    v_cndmask_b32_e64 v70, v114, 0, vcc
    v_cndmask_b32 v67, 0, v115, vcc
    v_cndmask_b32_e64 v71, v115, 0, vcc
    s_nop 1
    v_mfma_f32_32x32x16_bf16 v[164:179], v[64:67], v[72:75], 0
    v_mfma_f32_32x32x16_bf16 v[164:179], v[68:71], v[76:79], v[164:179]
    s_waitcnt lgkmcnt(0)
    v_pk_mul_f32 v[148:149], v[148:149], v[10:11] op_sel:[0,1] op_sel_hi:[1,1]
    v_pk_mul_f32 v[150:151], v[150:151], v[10:11] op_sel:[0,1] op_sel_hi:[1,1]
    v_pk_mul_f32 v[152:153], v[152:153], v[10:11] op_sel:[0,1] op_sel_hi:[1,1]
    v_pk_mul_f32 v[154:155], v[154:155], v[10:11] op_sel:[0,1] op_sel_hi:[1,1]
    v_pk_mul_f32 v[156:157], v[156:157], v[10:11] op_sel:[0,1] op_sel_hi:[1,1]
    v_pk_mul_f32 v[158:159], v[158:159], v[10:11] op_sel:[0,1] op_sel_hi:[1,1]
    v_pk_mul_f32 v[160:161], v[160:161], v[10:11] op_sel:[0,1] op_sel_hi:[1,1]
    v_pk_mul_f32 v[162:163], v[162:163], v[10:11] op_sel:[0,1] op_sel_hi:[1,1]
    v_pk_fma_f32 v[48:49], v[48:49], v[10:11], v[148:149] op_sel_hi:[1,0,1]
    v_pk_fma_f32 v[50:51], v[50:51], v[10:11], v[150:151] op_sel_hi:[1,0,1]
    v_pk_fma_f32 v[52:53], v[52:53], v[10:11], v[152:153] op_sel_hi:[1,0,1]
    v_pk_fma_f32 v[54:55], v[54:55], v[10:11], v[154:155] op_sel_hi:[1,0,1]
    v_pk_fma_f32 v[56:57], v[56:57], v[10:11], v[156:157] op_sel_hi:[1,0,1]
    v_pk_fma_f32 v[58:59], v[58:59], v[10:11], v[158:159] op_sel_hi:[1,0,1]
    v_pk_fma_f32 v[60:61], v[60:61], v[10:11], v[160:161] op_sel_hi:[1,0,1]
    v_pk_fma_f32 v[62:63], v[62:63], v[10:11], v[162:163] op_sel_hi:[1,0,1]
    v_cvt_pk_bf16_f32 v96, v48, v49
    v_cvt_pk_bf16_f32 v97, v50, v51
    v_cvt_pk_bf16_f32 v98, v52, v53
    v_cvt_pk_bf16_f32 v99, v54, v55
    v_cvt_pk_bf16_f32 v100, v56, v57
    v_cvt_pk_bf16_f32 v101, v58, v59
    v_cvt_pk_bf16_f32 v102, v60, v61
    v_cvt_pk_bf16_f32 v103, v62, v63
    ds_write_b64 v13, v[96:97] offset:128
    ds_write_b64 v13, v[98:99] offset:144
    ds_write_b64 v13, v[100:101] offset:160
    ds_write_b64 v13, v[102:103] offset:176
    v_max3_f32 v80, v164, v165, v166
    v_min3_f32 v81, v164, v165, v166
    v_max3_f32 v82, v172, v173, v174
    v_min3_f32 v83, v172, v173, v174
    v_max3_f32 v80, v80, v167, v168
    v_min3_f32 v81, v81, v167, v168
    v_max3_f32 v82, v82, v175, v176
    v_min3_f32 v83, v83, v175, v176
    v_max3_f32 v80, v80, v169, v170
    v_min3_f32 v81, v81, v169, v170
    v_max3_f32 v82, v82, v177, v178
    v_min3_f32 v83, v83, v177, v178
    v_max_f32 v80, v80, v171
    v_min_f32 v81, v81, v171
    v_max_f32 v82, v82, v179
    v_min_f32 v83, v83, v179
    v_mov_b32 v84, v80
    v_mov_b32 v85, v81
    v_mov_b32 v86, v82
    v_mov_b32 v87, v83
    s_nop 0
    v_permlane32_swap_b32 v84, v80
    v_permlane32_swap_b32 v85, v81
    v_permlane32_swap_b32 v86, v82
    v_permlane32_swap_b32 v87, v83
    s_nop 0
    v_max_f32 v80, v80, v84
    v_min_f32 v81, v81, v85
    v_max_f32 v82, v82, v86
    v_min_f32 v83, v83, v87
    v_mul_f32 v80, 0xbfb8aa3b, v80
    v_mul_f32 v81, 0x3fb8aa3b, v81
    v_mul_f32 v82, 0xbfb8aa3b, v82
    v_mul_f32 v83, 0x3fb8aa3b, v83
    v_pk_fma_f32 v[180:181], v[164:165], s[40:41], v[80:81] op_sel_hi:[1,0,0]
    v_pk_fma_f32 v[188:189], v[164:165], s[40:41], v[80:81] op_sel:[0,0,1] op_sel_hi:[1,0,1] neg_lo:[1,0,0] neg_hi:[1,0,0]
    v_pk_fma_f32 v[182:183], v[166:167], s[40:41], v[80:81] op_sel_hi:[1,0,0]
    v_pk_fma_f32 v[190:191], v[166:167], s[40:41], v[80:81] op_sel:[0,0,1] op_sel_hi:[1,0,1] neg_lo:[1,0,0] neg_hi:[1,0,0]
    v_pk_fma_f32 v[184:185], v[168:169], s[40:41], v[80:81] op_sel_hi:[1,0,0]
    v_pk_fma_f32 v[192:193], v[168:169], s[40:41], v[80:81] op_sel:[0,0,1] op_sel_hi:[1,0,1] neg_lo:[1,0,0] neg_hi:[1,0,0]
    v_pk_fma_f32 v[186:187], v[170:171], s[40:41], v[80:81] op_sel_hi:[1,0,0]
    v_pk_fma_f32 v[194:195], v[170:171], s[40:41], v[80:81] op_sel:[0,0,1] op_sel_hi:[1,0,1] neg_lo:[1,0,0] neg_hi:[1,0,0]
    v_pk_fma_f32 v[196:197], v[172:173], s[40:41], v[82:83] op_sel_hi:[1,0,0]
    v_pk_fma_f32 v[204:205], v[172:173], s[40:41], v[82:83] op_sel:[0,0,1] op_sel_hi:[1,0,1] neg_lo:[1,0,0] neg_hi:[1,0,0]
    v_pk_fma_f32 v[198:199], v[174:175], s[40:41], v[82:83] op_sel_hi:[1,0,0]
    v_pk_fma_f32 v[206:207], v[174:175], s[40:41], v[82:83] op_sel:[0,0,1] op_sel_hi:[1,0,1] neg_lo:[1,0,0] neg_hi:[1,0,0]
    v_pk_fma_f32 v[200:201], v[176:177], s[40:41], v[82:83] op_sel_hi:[1,0,0]
    v_pk_fma_f32 v[208:209], v[176:177], s[40:41], v[82:83] op_sel:[0,0,1] op_sel_hi:[1,0,1] neg_lo:[1,0,0] neg_hi:[1,0,0]
    v_pk_fma_f32 v[202:203], v[178:179], s[40:41], v[82:83] op_sel_hi:[1,0,0]
    v_pk_fma_f32 v[210:211], v[178:179], s[40:41], v[82:83] op_sel:[0,0,1] op_sel_hi:[1,0,1] neg_lo:[1,0,0] neg_hi:[1,0,0]
    v_exp_f32 v180, v180
    v_exp_f32 v181, v181
    v_exp_f32 v182, v182
    v_exp_f32 v183, v183
    v_exp_f32 v184, v184
    v_exp_f32 v185, v185
    v_exp_f32 v186, v186
    v_exp_f32 v187, v187
    v_exp_f32 v188, v188
    v_exp_f32 v189, v189
    v_exp_f32 v190, v190
    v_exp_f32 v191, v191
    v_exp_f32 v192, v192
    v_exp_f32 v193, v193
    v_exp_f32 v194, v194
    v_exp_f32 v195, v195
    v_exp_f32 v196, v196
    v_exp_f32 v197, v197
    v_exp_f32 v198, v198
    v_exp_f32 v199, v199
    v_exp_f32 v200, v200
    v_exp_f32 v201, v201
    v_exp_f32 v202, v202
    v_exp_f32 v203, v203
    v_exp_f32 v204, v204
    v_exp_f32 v205, v205
    v_exp_f32 v206, v206
    v_exp_f32 v207, v207
    v_exp_f32 v208, v208
    v_exp_f32 v209, v209
    v_exp_f32 v210, v210
    v_exp_f32 v211, v211
    v_pk_add_f32 v[84:85], v[180:181], v[182:183]
    v_pk_add_f32 v[86:87], v[188:189], v[190:191]
    v_pk_add_f32 v[88:89], v[196:197], v[198:199]
    v_pk_add_f32 v[90:91], v[204:205], v[206:207]
    v_pk_add_f32 v[84:85], v[84:85], v[184:185]
    v_pk_add_f32 v[86:87], v[86:87], v[192:193]
    v_pk_add_f32 v[88:89], v[88:89], v[200:201]
    v_pk_add_f32 v[90:91], v[90:91], v[208:209]
    v_pk_add_f32 v[84:85], v[84:85], v[186:187]
    v_pk_add_f32 v[86:87], v[86:87], v[194:195]
    v_pk_add_f32 v[88:89], v[88:89], v[202:203]
    v_pk_add_f32 v[90:91], v[90:91], v[210:211]
    v_add_f32 v84, v84, v85
    v_add_f32 v86, v86, v87
    v_add_f32 v88, v88, v89
    v_add_f32 v90, v90, v91
    v_mov_b32 v85, v84
    v_mov_b32 v87, v86
    v_mov_b32 v89, v88
    v_mov_b32 v91, v90
    s_nop 0
    v_permlane32_swap_b32 v84, v85
    v_permlane32_swap_b32 v86, v87
    v_permlane32_swap_b32 v88, v89
    v_permlane32_swap_b32 v90, v91
    s_nop 0
    v_add_f32 v84, v84, v85
    v_add_f32 v86, v86, v87
    v_add_f32 v88, v88, v89
    v_add_f32 v90, v90, v91
    v_rcp_f32 v84, v84
    v_rcp_f32 v86, v86
    v_rcp_f32 v88, v88
    v_rcp_f32 v90, v90
    v_pk_mul_f32 v[180:181], v[180:181], v[84:85] op_sel_hi:[1,0]
    v_pk_mul_f32 v[182:183], v[182:183], v[84:85] op_sel_hi:[1,0]
    v_pk_mul_f32 v[184:185], v[184:185], v[84:85] op_sel_hi:[1,0]
    v_pk_mul_f32 v[186:187], v[186:187], v[84:85] op_sel_hi:[1,0]
    v_pk_mul_f32 v[188:189], v[188:189], v[86:87] op_sel_hi:[1,0]
    v_pk_mul_f32 v[190:191], v[190:191], v[86:87] op_sel_hi:[1,0]
    v_pk_mul_f32 v[192:193], v[192:193], v[86:87] op_sel_hi:[1,0]
    v_pk_mul_f32 v[194:195], v[194:195], v[86:87] op_sel_hi:[1,0]
    v_pk_mul_f32 v[196:197], v[196:197], v[88:89] op_sel_hi:[1,0]
    v_pk_mul_f32 v[198:199], v[198:199], v[88:89] op_sel_hi:[1,0]
    v_pk_mul_f32 v[200:201], v[200:201], v[88:89] op_sel_hi:[1,0]
    v_pk_mul_f32 v[202:203], v[202:203], v[88:89] op_sel_hi:[1,0]
    v_pk_mul_f32 v[204:205], v[204:205], v[90:91] op_sel_hi:[1,0]
    v_pk_mul_f32 v[206:207], v[206:207], v[90:91] op_sel_hi:[1,0]
    v_pk_mul_f32 v[208:209], v[208:209], v[90:91] op_sel_hi:[1,0]
    v_pk_mul_f32 v[210:211], v[210:211], v[90:91] op_sel_hi:[1,0]
    v_cvt_pk_bf16_f32 v212, v180, v181
    v_cvt_pk_bf16_f32 v213, v182, v183
    v_cvt_pk_bf16_f32 v214, v184, v185
    v_cvt_pk_bf16_f32 v215, v186, v187
    v_cvt_pk_bf16_f32 v216, v188, v189
    v_cvt_pk_bf16_f32 v217, v190, v191
    v_cvt_pk_bf16_f32 v218, v192, v193
    v_cvt_pk_bf16_f32 v219, v194, v195
    v_cvt_pk_bf16_f32 v220, v196, v197
    v_cvt_pk_bf16_f32 v221, v198, v199
    v_cvt_pk_bf16_f32 v222, v200, v201
    v_cvt_pk_bf16_f32 v223, v202, v203
    v_cvt_pk_bf16_f32 v224, v204, v205
    v_cvt_pk_bf16_f32 v225, v206, v207
    v_cvt_pk_bf16_f32 v226, v208, v209
    v_cvt_pk_bf16_f32 v227, v210, v211
    ds_write_b64 v13, v[212:213] offset:0
    ds_write_b64 v13, v[214:215] offset:16
    ds_write_b64 v13, v[216:217] offset:32
    ds_write_b64 v13, v[218:219] offset:48
    ds_write_b64 v13, v[220:221] offset:64
    ds_write_b64 v13, v[222:223] offset:80
    ds_write_b64 v13, v[224:225] offset:96
    ds_write_b64 v13, v[226:227] offset:112
    v_lshrrev_b32 v3, 4, v1
    v_bfe_u32 v4, v1, 2, 2
    v_lshl_add_u32 v3, v3, 2, v4
    v_mul_u32_u24 v3, 200, v3
    v_and_b32 v4, 3, v1
    v_lshl_add_u32 v3, v4, 3, v3
    s_lshr_b32 s3, s7, 1
    s_lshl_b32 s3, s3, 5
    v_add_u32 v14, s3, v3
    s_lshr_b32 s3, s7, 2
    s_lshl_b32 s3, s3, 5
    s_add_u32 s3, s3, 128
    v_add_u32 v15, s3, v3
    s_waitcnt lgkmcnt(0)
    s_barrier
    ds_read_b64_tr_b16 v[132:133], v14 offset:0
    ds_read_b64_tr_b16 v[134:135], v14 offset:3200
    ds_read_b64_tr_b16 v[136:137], v14 offset:6400
    ds_read_b64_tr_b16 v[138:139], v14 offset:9600
    ds_read_b64_tr_b16 v[140:141], v14 offset:12800
    ds_read_b64_tr_b16 v[142:143], v14 offset:16000
    ds_read_b64_tr_b16 v[144:145], v14 offset:19200
    ds_read_b64_tr_b16 v[146:147], v14 offset:22400
    ds_read_b64_tr_b16 v[148:149], v14 offset:25600
    ds_read_b64_tr_b16 v[150:151], v14 offset:28800
    ds_read_b64_tr_b16 v[152:153], v14 offset:32000
    ds_read_b64_tr_b16 v[154:155], v14 offset:35200
    ds_read_b64_tr_b16 v[156:157], v14 offset:38400
    ds_read_b64_tr_b16 v[158:159], v14 offset:41600
    ds_read_b64_tr_b16 v[160:161], v14 offset:44800
    ds_read_b64_tr_b16 v[162:163], v14 offset:48000
    s_and_b32 s3, s7, 1
    s_cmp_eq_u32 s3, 0
    s_cbranch_scc0 K1_ZBLK
    ds_read_b64_tr_b16 v[164:165], v15 offset:0
    ds_read_b64_tr_b16 v[166:167], v15 offset:3200
    ds_read_b64_tr_b16 v[168:169], v15 offset:6400
    ds_read_b64_tr_b16 v[170:171], v15 offset:9600
    ds_read_b64_tr_b16 v[172:173], v15 offset:12800
    ds_read_b64_tr_b16 v[174:175], v15 offset:16000
    ds_read_b64_tr_b16 v[176:177], v15 offset:19200
    ds_read_b64_tr_b16 v[178:179], v15 offset:22400
    s_waitcnt lgkmcnt(0)
    v_mfma_f32_16x16x32_bf16 v[104:107], v[132:135], v[164:167], 0
    v_mfma_f32_16x16x32_bf16 v[104:107], v[136:139], v[168:171], v[104:107]
    v_mfma_f32_16x16x32_bf16 v[104:107], v[140:143], v[172:175], v[104:107]
    v_mfma_f32_16x16x32_bf16 v[104:107], v[144:147], v[176:179], v[104:107]
    ds_read_b64_tr_b16 v[164:165], v15 offset:25600
    ds_read_b64_tr_b16 v[166:167], v15 offset:28800
    ds_read_b64_tr_b16 v[168:169], v15 offset:32000
    ds_read_b64_tr_b16 v[170:171], v15 offset:35200
    ds_read_b64_tr_b16 v[172:173], v15 offset:38400
    ds_read_b64_tr_b16 v[174:175], v15 offset:41600
    ds_read_b64_tr_b16 v[176:177], v15 offset:44800
    ds_read_b64_tr_b16 v[178:179], v15 offset:48000
    s_waitcnt lgkmcnt(0)
    v_mfma_f32_16x16x32_bf16 v[104:107], v[148:151], v[164:167], v[104:107]
    v_mfma_f32_16x16x32_bf16 v[104:107], v[152:155], v[168:171], v[104:107]
    v_mfma_f32_16x16x32_bf16 v[104:107], v[156:159], v[172:175], v[104:107]
    v_mfma_f32_16x16x32_bf16 v[104:107], v[160:163], v[176:179], v[104:107]
    s_branch K1_KVST
K1_ZBLK:
    v_mov_b32 v164, s58
    v_mov_b32 v165, s58
    v_mov_b32 v166, s58
    v_mov_b32 v167, s58
    s_waitcnt lgkmcnt(0)
    v_mfma_f32_16x16x32_bf16 v[104:107], v[132:135], v[164:167], 0
    v_mfma_f32_16x16x32_bf16 v[104:107], v[136:139], v[164:167], v[104:107]
    v_mfma_f32_16x16x32_bf16 v[104:107], v[140:143], v[164:167], v[104:107]
    v_mfma_f32_16x16x32_bf16 v[104:107], v[144:147], v[164:167], v[104:107]
    v_mfma_f32_16x16x32_bf16 v[104:107], v[148:151], v[164:167], v[104:107]
    v_mfma_f32_16x16x32_bf16 v[104:107], v[152:155], v[164:167], v[104:107]
    v_mfma_f32_16x16x32_bf16 v[104:107], v[156:159], v[164:167], v[104:107]
    v_mfma_f32_16x16x32_bf16 v[104:107], v[160:163], v[164:167], v[104:107]
K1_KVST:
    s_nop 7
    buffer_store_dwordx4 v[104:107], v7, s[24:27], 0 offen sc1
    v_pk_mul_f32 v[116:117], v[116:117], v[10:11] op_sel:[0,1] op_sel_hi:[1,1]
    v_pk_mul_f32 v[118:119], v[118:119], v[10:11] op_sel:[0,1] op_sel_hi:[1,1]
    v_pk_mul_f32 v[120:121], v[120:121], v[10:11] op_sel:[0,1] op_sel_hi:[1,1]
    v_pk_mul_f32 v[122:123], v[122:123], v[10:11] op_sel:[0,1] op_sel_hi:[1,1]
    v_pk_mul_f32 v[124:125], v[124:125], v[10:11] op_sel:[0,1] op_sel_hi:[1,1]
    v_pk_mul_f32 v[126:127], v[126:127], v[10:11] op_sel:[0,1] op_sel_hi:[1,1]
    v_pk_mul_f32 v[128:129], v[128:129], v[10:11] op_sel:[0,1] op_sel_hi:[1,1]
    v_pk_mul_f32 v[130:131], v[130:131], v[10:11] op_sel:[0,1] op_sel_hi:[1,1]
    v_pk_fma_f32 v[16:17], v[16:17], v[10:11], v[116:117] op_sel_hi:[1,0,1]
    v_pk_fma_f32 v[18:19], v[18:19], v[10:11], v[118:119] op_sel_hi:[1,0,1]
    v_pk_fma_f32 v[20:21], v[20:21], v[10:11], v[120:121] op_sel_hi:[1,0,1]
    v_pk_fma_f32 v[22:23], v[22:23], v[10:11], v[122:123] op_sel_hi:[1,0,1]
    v_pk_fma_f32 v[24:25], v[24:25], v[10:11], v[124:125] op_sel_hi:[1,0,1]
    v_pk_fma_f32 v[26:27], v[26:27], v[10:11], v[126:127] op_sel_hi:[1,0,1]
    v_pk_fma_f32 v[28:29], v[28:29], v[10:11], v[128:129] op_sel_hi:[1,0,1]
    v_pk_fma_f32 v[30:31], v[30:31], v[10:11], v[130:131] op_sel_hi:[1,0,1]
    v_cvt_pk_bf16_f32 v72, v16, v17
    v_cvt_pk_bf16_f32 v73, v18, v19
    v_cvt_pk_bf16_f32 v74, v20, v21
    v_cvt_pk_bf16_f32 v75, v22, v23
    v_cvt_pk_bf16_f32 v76, v24, v25
    v_cvt_pk_bf16_f32 v77, v26, v27
    v_cvt_pk_bf16_f32 v78, v28, v29
    v_cvt_pk_bf16_f32 v79, v30, v31
    s_nop 1
    v_mfma_f32_32x32x16_bf16 v[164:179], v[64:67], v[72:75], 0
    v_mfma_f32_32x32x16_bf16 v[164:179], v[68:71], v[76:79], v[164:179]
    s_lshr_b32 s92, s2, 6
    s_and_b32 s3, s2, 7
    s_lshl_b32 s3, s3, 2
    s_add_u32 s92, s92, s3
    s_bfe_u32 s93, s2, 0x30003
    s_mul_i32 s94, s7, 12288
    s_add_u32 s94, s94, 57344
    v_lshrrev_b32 v3, 3, v1
    v_lshl_add_u32 v3, v2, 4, v3
    v_lshlrev_b32 v3, 10, v3
    v_bfe_u32 v4, v1, 4, 1
    v_lshlrev_b32 v4, 2, v4
    v_and_b32 v5, 7, v1
    v_xor_b32 v4, v4, v5
    v_lshlrev_b32 v4, 4, v4
    s_lshl_b32 s3, s93, 7
    v_add3_u32 v229, v3, v4, s3
    v_add_u32 v230, 7168, v229
    s_mov_b32 s12, s84
    s_mov_b32 s13, s85
    s_mov_b32 s14, 0x80000
    s_mov_b32 s15, 0x00020000
    s_mov_b32 s16, s88
    s_mov_b32 s17, s89
    s_mov_b32 s18, 0x158000
    s_mov_b32 s19, 0x00020000
    v_lshlrev_b32 v3, 4, v1
    v_lshlrev_b32 v4, 16, v2
    s_lshl_b32 s3, s92, 11
    v_add3_u32 v228, v3, v4, s3
    v_lshrrev_b32 v3, 5, v1
    v_bfe_u32 v4, v1, 2, 2
    v_lshl_add_u32 v3, v3, 2, v4
    v_lshlrev_b32 v3, 7, v3
    v_bfe_u32 v4, v1, 4, 1
    v_bfe_u32 v5, v1, 1, 1
    v_lshl_add_u32 v4, v4, 1, v5
    v_bfe_u32 v5, v1, 3, 1
    v_lshl_add_u32 v4, v5, 2, v4
    v_and_b32 v5, 1, v1
    v_lshlrev_b32 v5, 3, v5
    v_lshl_add_u32 v4, v4, 4, v5
    v_add3_u32 v231, v3, v4, s94
    v_xor_b32 v232, 64, v231
    v_bfe_u32 v3, v1, 4, 1
    v_lshlrev_b32 v3, 6, v3
    v_lshrrev_b32 v4, 5, v1
    v_lshl_add_u32 v3, v4, 4, v3
    v_and_b32 v4, 15, v1
    v_add_u32 v3, v3, v4
    s_lshr_b32 s3, s7, 1
    s_lshl_b32 s3, s3, 7
    s_and_b32 s4, s7, 1
    s_lshl_b32 s4, s4, 5
    s_add_u32 s3, s3, s4
    v_add_u32 v3, s3, v3
    s_lshl_b32 s3, s38, 16
    v_lshl_add_u32 v14, v3, 4, s3
    s_lshr_b32 s3, s7, 1
    s_lshl_b32 s3, s3, 10
    s_and_b32 s4, s7, 1
    s_lshl_b32 s4, s4, 3
    s_add_u32 s3, s3, s4
    s_add_u32 s3, s3, 51200
    v_lshl_add_u32 v15, v1, 4, s3
    v_max3_f32 v80, v164, v165, v166
    v_min3_f32 v81, v164, v165, v166
    v_max3_f32 v82, v172, v173, v174
    v_min3_f32 v83, v172, v173, v174
    v_max3_f32 v80, v80, v167, v168
    v_min3_f32 v81, v81, v167, v168
    v_max3_f32 v82, v82, v175, v176
    v_min3_f32 v83, v83, v175, v176
    v_max3_f32 v80, v80, v169, v170
    v_min3_f32 v81, v81, v169, v170
    v_max3_f32 v82, v82, v177, v178
    v_min3_f32 v83, v83, v177, v178
    v_max_f32 v80, v80, v171
    v_min_f32 v81, v81, v171
    v_max_f32 v82, v82, v179
    v_min_f32 v83, v83, v179
    v_mov_b32 v84, v80
    v_mov_b32 v85, v81
    v_mov_b32 v86, v82
    v_mov_b32 v87, v83
    s_nop 0
    v_permlane32_swap_b32 v84, v80
    v_permlane32_swap_b32 v85, v81
    v_permlane32_swap_b32 v86, v82
    v_permlane32_swap_b32 v87, v83
    s_nop 0
    v_max_f32 v80, v80, v84
    v_min_f32 v81, v81, v85
    v_max_f32 v82, v82, v86
    v_min_f32 v83, v83, v87
    v_mul_f32 v80, 0xbfb8aa3b, v80
    v_mul_f32 v81, 0x3fb8aa3b, v81
    v_mul_f32 v82, 0xbfb8aa3b, v82
    v_mul_f32 v83, 0x3fb8aa3b, v83
    v_pk_fma_f32 v[180:181], v[164:165], s[40:41], v[80:81] op_sel_hi:[1,0,0]
    v_pk_fma_f32 v[188:189], v[164:165], s[40:41], v[80:81] op_sel:[0,0,1] op_sel_hi:[1,0,1] neg_lo:[1,0,0] neg_hi:[1,0,0]
    v_pk_fma_f32 v[182:183], v[166:167], s[40:41], v[80:81] op_sel_hi:[1,0,0]
    v_pk_fma_f32 v[190:191], v[166:167], s[40:41], v[80:81] op_sel:[0,0,1] op_sel_hi:[1,0,1] neg_lo:[1,0,0] neg_hi:[1,0,0]
    v_pk_fma_f32 v[184:185], v[168:169], s[40:41], v[80:81] op_sel_hi:[1,0,0]
    v_pk_fma_f32 v[192:193], v[168:169], s[40:41], v[80:81] op_sel:[0,0,1] op_sel_hi:[1,0,1] neg_lo:[1,0,0] neg_hi:[1,0,0]
    v_pk_fma_f32 v[186:187], v[170:171], s[40:41], v[80:81] op_sel_hi:[1,0,0]
    v_pk_fma_f32 v[194:195], v[170:171], s[40:41], v[80:81] op_sel:[0,0,1] op_sel_hi:[1,0,1] neg_lo:[1,0,0] neg_hi:[1,0,0]
    v_pk_fma_f32 v[196:197], v[172:173], s[40:41], v[82:83] op_sel_hi:[1,0,0]
    v_pk_fma_f32 v[204:205], v[172:173], s[40:41], v[82:83] op_sel:[0,0,1] op_sel_hi:[1,0,1] neg_lo:[1,0,0] neg_hi:[1,0,0]
    v_pk_fma_f32 v[198:199], v[174:175], s[40:41], v[82:83] op_sel_hi:[1,0,0]
    v_pk_fma_f32 v[206:207], v[174:175], s[40:41], v[82:83] op_sel:[0,0,1] op_sel_hi:[1,0,1] neg_lo:[1,0,0] neg_hi:[1,0,0]
    v_pk_fma_f32 v[200:201], v[176:177], s[40:41], v[82:83] op_sel_hi:[1,0,0]
    v_pk_fma_f32 v[208:209], v[176:177], s[40:41], v[82:83] op_sel:[0,0,1] op_sel_hi:[1,0,1] neg_lo:[1,0,0] neg_hi:[1,0,0]
    v_pk_fma_f32 v[202:203], v[178:179], s[40:41], v[82:83] op_sel_hi:[1,0,0]
    v_pk_fma_f32 v[210:211], v[178:179], s[40:41], v[82:83] op_sel:[0,0,1] op_sel_hi:[1,0,1] neg_lo:[1,0,0] neg_hi:[1,0,0]
    v_exp_f32 v180, v180
    v_exp_f32 v181, v181
    v_exp_f32 v182, v182
    s_add_u32 m0, s94, 0
    s_mov_b32 s95, 0x0
    buffer_load_dwordx4 v229, s[16:19], s95 offen lds
    buffer_load_dwordx4 v230, s[16:19], s95 offen offset:1024 lds
    v_exp_f32 v183, v183
    v_exp_f32 v184, v184
    v_exp_f32 v185, v185
    v_exp_f32 v186, v186
    v_exp_f32 v187, v187
    s_add_u32 m0, s94, 2048
    s_mov_b32 s95, 0x20000
    buffer_load_dwordx4 v229, s[16:19], s95 offen lds
    buffer_load_dwordx4 v230, s[16:19], s95 offen offset:1024 lds
    v_exp_f32 v188, v188
    v_exp_f32 v189, v189
    v_exp_f32 v190, v190
    v_exp_f32 v191, v191
    v_exp_f32 v192, v192
    s_add_u32 m0, s94, 4096
    s_mov_b32 s95, 0x40000
    buffer_load_dwordx4 v229, s[16:19], s95 offen lds
    buffer_load_dwordx4 v230, s[16:19], s95 offen offset:1024 lds
    v_exp_f32 v193, v193
    v_exp_f32 v194, v194
    v_exp_f32 v195, v195
    v_exp_f32 v196, v196
    v_exp_f32 v197, v197
    s_add_u32 m0, s94, 6144
    s_mov_b32 s95, 0x60000
    buffer_load_dwordx4 v229, s[16:19], s95 offen lds
    buffer_load_dwordx4 v230, s[16:19], s95 offen offset:1024 lds
    v_exp_f32 v198, v198
    v_exp_f32 v199, v199
    v_exp_f32 v200, v200
    v_exp_f32 v201, v201
    v_exp_f32 v202, v202
    s_add_u32 m0, s94, 8192
    s_mov_b32 s95, 0x80000
    buffer_load_dwordx4 v229, s[16:19], s95 offen lds
    buffer_load_dwordx4 v230, s[16:19], s95 offen offset:1024 lds
    v_exp_f32 v203, v203
    v_exp_f32 v204, v204
    v_exp_f32 v205, v205
    v_exp_f32 v206, v206
    v_exp_f32 v207, v207
    s_add_u32 m0, s94, 10240
    s_mov_b32 s95, 0xa0000
    buffer_load_dwordx4 v229, s[16:19], s95 offen lds
    buffer_load_dwordx4 v230, s[16:19], s95 offen offset:1024 lds
    v_exp_f32 v208, v208
    v_exp_f32 v209, v209
    v_exp_f32 v210, v210
    v_exp_f32 v211, v211
    buffer_load_dword v6, v233, s[24:27], 0 offen sc1
    s_mov_b32 s3, 0
    buffer_load_dwordx4 v[116:119], v14, s[24:27], s3 offen sc1
    s_mov_b32 s3, 8192
    buffer_load_dwordx4 v[120:123], v14, s[24:27], s3 offen sc1
    s_mov_b32 s3, 16384
    buffer_load_dwordx4 v[124:127], v14, s[24:27], s3 offen sc1
    s_mov_b32 s3, 24576
    buffer_load_dwordx4 v[128:131], v14, s[24:27], s3 offen sc1
    s_mov_b32 s3, 32768
    buffer_load_dwordx4 v[132:135], v14, s[24:27], s3 offen sc1
    s_mov_b32 s3, 40960
    buffer_load_dwordx4 v[136:139], v14, s[24:27], s3 offen sc1
    s_mov_b32 s3, 49152
    buffer_load_dwordx4 v[140:143], v14, s[24:27], s3 offen sc1
    s_mov_b32 s3, 57344
    buffer_load_dwordx4 v[144:147], v14, s[24:27], s3 offen sc1
    v_pk_add_f32 v[84:85], v[180:181], v[182:183]
    v_pk_add_f32 v[86:87], v[188:189], v[190:191]
    v_pk_add_f32 v[88:89], v[196:197], v[198:199]
    v_pk_add_f32 v[90:91], v[204:205], v[206:207]
    v_pk_add_f32 v[84:85], v[84:85], v[184:185]
    v_pk_add_f32 v[86:87], v[86:87], v[192:193]
    v_pk_add_f32 v[88:89], v[88:89], v[200:201]
    v_pk_add_f32 v[90:91], v[90:91], v[208:209]
    v_pk_add_f32 v[84:85], v[84:85], v[186:187]
    v_pk_add_f32 v[86:87], v[86:87], v[194:195]
    v_pk_add_f32 v[88:89], v[88:89], v[202:203]
    v_pk_add_f32 v[90:91], v[90:91], v[210:211]
    v_add_f32 v84, v84, v85
    v_add_f32 v86, v86, v87
    v_add_f32 v88, v88, v89
    v_add_f32 v90, v90, v91
    v_mov_b32 v85, v84
    v_mov_b32 v87, v86
    v_mov_b32 v89, v88
    v_mov_b32 v91, v90
    s_nop 0
    v_permlane32_swap_b32 v84, v85
    v_permlane32_swap_b32 v86, v87
    v_permlane32_swap_b32 v88, v89
    v_permlane32_swap_b32 v90, v91
    s_nop 0
    v_add_f32 v84, v84, v85
    v_add_f32 v86, v86, v87
    v_add_f32 v88, v88, v89
    v_add_f32 v90, v90, v91
    v_rcp_f32 v84, v84
    v_rcp_f32 v86, v86
    v_rcp_f32 v88, v88
    v_rcp_f32 v90, v90
    v_pk_mul_f32 v[180:181], v[180:181], v[84:85] op_sel_hi:[1,0]
    v_pk_mul_f32 v[182:183], v[182:183], v[84:85] op_sel_hi:[1,0]
    v_pk_mul_f32 v[184:185], v[184:185], v[84:85] op_sel_hi:[1,0]
    v_pk_mul_f32 v[186:187], v[186:187], v[84:85] op_sel_hi:[1,0]
    v_pk_mul_f32 v[188:189], v[188:189], v[86:87] op_sel_hi:[1,0]
    v_pk_mul_f32 v[190:191], v[190:191], v[86:87] op_sel_hi:[1,0]
    v_pk_mul_f32 v[192:193], v[192:193], v[86:87] op_sel_hi:[1,0]
    v_pk_mul_f32 v[194:195], v[194:195], v[86:87] op_sel_hi:[1,0]
    v_pk_mul_f32 v[196:197], v[196:197], v[88:89] op_sel_hi:[1,0]
    v_pk_mul_f32 v[198:199], v[198:199], v[88:89] op_sel_hi:[1,0]
    v_pk_mul_f32 v[200:201], v[200:201], v[88:89] op_sel_hi:[1,0]
    v_pk_mul_f32 v[202:203], v[202:203], v[88:89] op_sel_hi:[1,0]
    v_pk_mul_f32 v[204:205], v[204:205], v[90:91] op_sel_hi:[1,0]
    v_pk_mul_f32 v[206:207], v[206:207], v[90:91] op_sel_hi:[1,0]
    v_pk_mul_f32 v[208:209], v[208:209], v[90:91] op_sel_hi:[1,0]
    v_pk_mul_f32 v[210:211], v[210:211], v[90:91] op_sel_hi:[1,0]
    v_cvt_pk_bf16_f32 v212, v180, v181
    v_cvt_pk_bf16_f32 v213, v182, v183
    v_cvt_pk_bf16_f32 v214, v184, v185
    v_cvt_pk_bf16_f32 v215, v186, v187
    v_cvt_pk_bf16_f32 v216, v188, v189
    v_cvt_pk_bf16_f32 v217, v190, v191
    v_cvt_pk_bf16_f32 v218, v192, v193
    v_cvt_pk_bf16_f32 v219, v194, v195
    v_cvt_pk_bf16_f32 v220, v196, v197
    v_cvt_pk_bf16_f32 v221, v198, v199
    v_cvt_pk_bf16_f32 v222, v200, v201
    v_cvt_pk_bf16_f32 v223, v202, v203
    v_cvt_pk_bf16_f32 v224, v204, v205
    v_cvt_pk_bf16_f32 v225, v206, v207
    v_cvt_pk_bf16_f32 v226, v208, v209
    v_cvt_pk_bf16_f32 v227, v210, v211
    s_mov_b32 s4, 0
    s_branch K1_POLL1
K1_POLL:
    s_mov_b32 s3, 0
    buffer_load_dwordx4 v[116:119], v14, s[24:27], s3 offen sc1
    s_mov_b32 s3, 8192
    buffer_load_dwordx4 v[120:123], v14, s[24:27], s3 offen sc1
    s_mov_b32 s3, 16384
    buffer_load_dwordx4 v[124:127], v14, s[24:27], s3 offen sc1
    s_mov_b32 s3, 24576
    buffer_load_dwordx4 v[128:131], v14, s[24:27], s3 offen sc1
    s_mov_b32 s3, 32768
    buffer_load_dwordx4 v[132:135], v14, s[24:27], s3 offen sc1
    s_mov_b32 s3, 40960
    buffer_load_dwordx4 v[136:139], v14, s[24:27], s3 offen sc1
    s_mov_b32 s3, 49152
    buffer_load_dwordx4 v[140:143], v14, s[24:27], s3 offen sc1
    s_mov_b32 s3, 57344
    buffer_load_dwordx4 v[144:147], v14, s[24:27], s3 offen sc1
K1_POLL1:
    v_mov_b32 v3, 0
    s_add_u32 s4, s4, 1
    s_waitcnt vmcnt(7)
    v_max3_u32 v3, v3, v116, v117
    v_max3_u32 v3, v3, v118, v119
    s_waitcnt vmcnt(6)
    v_max3_u32 v3, v3, v120, v121
    v_max3_u32 v3, v3, v122, v123
    s_waitcnt vmcnt(5)
    v_max3_u32 v3, v3, v124, v125
    v_max3_u32 v3, v3, v126, v127
    s_waitcnt vmcnt(4)
    v_max3_u32 v3, v3, v128, v129
    v_max3_u32 v3, v3, v130, v131
    s_waitcnt vmcnt(3)
    v_max3_u32 v3, v3, v132, v133
    v_max3_u32 v3, v3, v134, v135
    s_waitcnt vmcnt(2)
    v_max3_u32 v3, v3, v136, v137
    v_max3_u32 v3, v3, v138, v139
    s_waitcnt vmcnt(1)
    v_max3_u32 v3, v3, v140, v141
    v_max3_u32 v3, v3, v142, v143
    s_waitcnt vmcnt(0)
    v_max3_u32 v3, v3, v144, v145
    v_max3_u32 v3, v3, v146, v147
    v_cmp_eq_u32 vcc, -1, v3
    s_cmp_lt_u32 s4, 0x20000
    s_cbranch_scc0 K1_NOPOLL
    s_cbranch_vccnz K1_POLL
K1_NOPOLL:
    v_pk_add_f32 v[116:117], v[116:117], v[120:121]
    v_pk_add_f32 v[118:119], v[118:119], v[122:123]
    v_pk_add_f32 v[116:117], v[116:117], v[124:125]
    v_pk_add_f32 v[118:119], v[118:119], v[126:127]
    v_pk_add_f32 v[116:117], v[116:117], v[128:129]
    v_pk_add_f32 v[118:119], v[118:119], v[130:131]
    v_pk_add_f32 v[116:117], v[116:117], v[132:133]
    v_pk_add_f32 v[118:119], v[118:119], v[134:135]
    v_pk_add_f32 v[116:117], v[116:117], v[136:137]
    v_pk_add_f32 v[118:119], v[118:119], v[138:139]
    v_pk_add_f32 v[116:117], v[116:117], v[140:141]
    v_pk_add_f32 v[118:119], v[118:119], v[142:143]
    v_pk_add_f32 v[116:117], v[116:117], v[144:145]
    v_pk_add_f32 v[118:119], v[118:119], v[146:147]
    v_cvt_pk_bf16_f32 v4, v116, v117
    v_cvt_pk_bf16_f32 v5, v118, v119
    ds_write_b64 v15, v[4:5]
    v_cmp_eq_u32 vcc, s36, v6
    s_cmp_eq_u32 s7, 0
    s_cbranch_scc0 K1_QHOK
    s_andn2_b32 s3, 0x7fff0000, vcc_hi
    s_cbranch_scc0 K1_QHOK
    s_mov_b32 s4, 0
K1_QH2:
    buffer_load_dword v3, v233, s[24:27], 0 offen sc1
    s_add_u32 s4, s4, 1
    s_waitcnt vmcnt(0)
    v_cmp_eq_u32 vcc, s36, v3
    s_cmp_lt_u32 s4, 0x40000
    s_cbranch_scc0 K1_QHOK
    s_andn2_b32 s3, 2147418112, vcc_hi
    s_cbranch_scc0 K1_QHOK
    s_movk_i32 s3, 20
K1_QH2D:
    s_sub_u32 s3, s3, 1
    s_cbranch_scc0 K1_QH2D
    s_branch K1_QH2
K1_QHOK:
    v_lshlrev_b32 v3, 4, v1
    s_waitcnt lgkmcnt(0)
    s_barrier
    ds_read_b128 v[116:119], v3 offset:51200
    ds_read_b128 v[120:123], v3 offset:52224
    ds_read_b128 v[124:127], v3 offset:53248
    ds_read_b128 v[128:131], v3 offset:54272
    s_lshl_b32 s44, s38, 17
    s_waitcnt lgkmcnt(2)
    v_mfma_f32_32x32x16_bf16 v[16:31], v[116:119], v[212:215], 0
    v_mfma_f32_32x32x16_bf16 v[16:31], v[120:123], v[216:219], v[16:31]
    s_waitcnt lgkmcnt(0)
    v_mfma_f32_32x32x16_bf16 v[32:47], v[124:127], v[220:223], 0
    v_mfma_f32_32x32x16_bf16 v[32:47], v[128:131], v[224:227], v[32:47]
    s_nop 9
    v_add_f32 v24, 0x358637bd, v24
    v_rcp_f32 v24, v24
    s_nop 0
    v_pk_mul_f32 v[16:17], v[16:17], v[24:25] op_sel_hi:[1,0]
    v_pk_mul_f32 v[18:19], v[18:19], v[24:25] op_sel_hi:[1,0]
    v_pk_mul_f32 v[20:21], v[20:21], v[24:25] op_sel_hi:[1,0]
    v_pk_mul_f32 v[22:23], v[22:23], v[24:25] op_sel_hi:[1,0]
    v_cvt_pk_bf16_f32 v96, v16, v17
    v_cvt_pk_bf16_f32 v97, v18, v19
    v_cvt_pk_bf16_f32 v98, v20, v21
    v_cvt_pk_bf16_f32 v99, v22, v23
    buffer_store_dwordx4 v[96:99], v12, s[20:23], s44 offen sc1
    s_add_u32 s44, s44, 0x10000
    v_add_f32 v40, 0x358637bd, v40
    v_rcp_f32 v40, v40
    s_nop 0
    v_pk_mul_f32 v[32:33], v[32:33], v[40:41] op_sel_hi:[1,0]
    v_pk_mul_f32 v[34:35], v[34:35], v[40:41] op_sel_hi:[1,0]
    v_pk_mul_f32 v[36:37], v[36:37], v[40:41] op_sel_hi:[1,0]
    v_pk_mul_f32 v[38:39], v[38:39], v[40:41] op_sel_hi:[1,0]
    v_cvt_pk_bf16_f32 v100, v32, v33
    v_cvt_pk_bf16_f32 v101, v34, v35
    v_cvt_pk_bf16_f32 v102, v36, v37
    v_cvt_pk_bf16_f32 v103, v38, v39
    buffer_store_dwordx4 v[100:103], v12, s[20:23], s44 offen sc1
    s_add_u32 s44, s44, 0x10000
K1_FIN:
    s_mov_b32 s95, 0x200000
    buffer_load_dwordx4 v[148:151], v228, s[20:23], s95 offen offset:0
    buffer_load_dwordx4 v[152:155], v228, s[20:23], s95 offen offset:1024
    s_mov_b32 s95, 0x280000
    buffer_load_dwordx4 v[156:159], v228, s[20:23], s95 offen offset:0
    buffer_load_dwordx4 v[160:163], v228, s[20:23], s95 offen offset:1024
    s_mov_b32 s95, 0x300000
    buffer_load_dwordx4 v[164:167], v228, s[20:23], s95 offen offset:0
    buffer_load_dwordx4 v[168:171], v228, s[20:23], s95 offen offset:1024
    s_mov_b32 s95, 0x380000
    buffer_load_dwordx4 v[172:175], v228, s[20:23], s95 offen offset:0
    buffer_load_dwordx4 v[176:179], v228, s[20:23], s95 offen offset:1024
    s_mov_b32 s95, 0x400000
    buffer_load_dwordx4 v[180:183], v228, s[20:23], s95 offen offset:0
    buffer_load_dwordx4 v[184:187], v228, s[20:23], s95 offen offset:1024
    s_mov_b32 s95, 0x480000
    buffer_load_dwordx4 v[188:191], v228, s[20:23], s95 offen offset:0
    buffer_load_dwordx4 v[192:195], v228, s[20:23], s95 offen offset:1024
    s_cmp_lt_u32 s6, 16
    s_cselect_b32 s4, 0, 0x10000000
    v_or_b32 v8, s4, v234
    v_mov_b32 v9, s36
    s_waitcnt vmcnt(12)
    s_barrier
    buffer_store_dword v9, v8, s[24:27], 0 offen sc1
    ds_read_b64_tr_b16 v[80:81], v231 offset:0
    ds_read_b64_tr_b16 v[82:83], v231 offset:1024
    ds_read_b64_tr_b16 v[84:85], v232 offset:0
    ds_read_b64_tr_b16 v[86:87], v232 offset:1024
    s_waitcnt vmcnt(11)
    ds_read_b64_tr_b16 v[88:89], v231 offset:2048
    ds_read_b64_tr_b16 v[90:91], v231 offset:3072
    ds_read_b64_tr_b16 v[92:93], v232 offset:2048
    ds_read_b64_tr_b16 v[94:95], v232 offset:3072
    s_waitcnt lgkmcnt(4)
    v_mfma_f32_32x32x16_bf16 v[16:31], v[80:83], v[148:151], 0
    v_mfma_f32_32x32x16_bf16 v[32:47], v[80:83], v[152:155], 0
    v_mfma_f32_32x32x16_bf16 v[48:63], v[84:87], v[148:151], 0
    v_mfma_f32_32x32x16_bf16 v[64:79], v[84:87], v[152:155], 0
    s_add_u32 m0, s94, 0
    s_mov_b32 s95, 0xc0000
    buffer_load_dwordx4 v229, s[16:19], s95 offen lds
    buffer_load_dwordx4 v230, s[16:19], s95 offen offset:1024 lds
    s_mov_b32 s95, 0x500000
    buffer_load_dwordx4 v[148:151], v228, s[20:23], s95 offen offset:0
    buffer_load_dwordx4 v[152:155], v228, s[20:23], s95 offen offset:1024
    s_waitcnt vmcnt(13)
    ds_read_b64_tr_b16 v[80:81], v231 offset:4096
    ds_read_b64_tr_b16 v[82:83], v231 offset:5120
    ds_read_b64_tr_b16 v[84:85], v232 offset:4096
    ds_read_b64_tr_b16 v[86:87], v232 offset:5120
    s_waitcnt lgkmcnt(4)
    v_mfma_f32_32x32x16_bf16 v[16:31], v[88:91], v[156:159], v[16:31]
    v_mfma_f32_32x32x16_bf16 v[32:47], v[88:91], v[160:163], v[32:47]
    v_mfma_f32_32x32x16_bf16 v[48:63], v[92:95], v[156:159], v[48:63]
    v_mfma_f32_32x32x16_bf16 v[64:79], v[92:95], v[160:163], v[64:79]
    s_add_u32 m0, s94, 2048
    s_mov_b32 s95, 0xe0000
    buffer_load_dwordx4 v229, s[16:19], s95 offen lds
    buffer_load_dwordx4 v230, s[16:19], s95 offen offset:1024 lds
    s_mov_b32 s95, 0x580000
    buffer_load_dwordx4 v[156:159], v228, s[20:23], s95 offen offset:0
    buffer_load_dwordx4 v[160:163], v228, s[20:23], s95 offen offset:1024
    s_waitcnt vmcnt(15)
    ds_read_b64_tr_b16 v[88:89], v231 offset:6144
    ds_read_b64_tr_b16 v[90:91], v231 offset:7168
    ds_read_b64_tr_b16 v[92:93], v232 offset:6144
    ds_read_b64_tr_b16 v[94:95], v232 offset:7168
    s_waitcnt lgkmcnt(4)
    v_mfma_f32_32x32x16_bf16 v[16:31], v[80:83], v[164:167], v[16:31]
    v_mfma_f32_32x32x16_bf16 v[32:47], v[80:83], v[168:171], v[32:47]
    v_mfma_f32_32x32x16_bf16 v[48:63], v[84:87], v[164:167], v[48:63]
    v_mfma_f32_32x32x16_bf16 v[64:79], v[84:87], v[168:171], v[64:79]
    s_add_u32 m0, s94, 4096
    s_mov_b32 s95, 0x100000
    buffer_load_dwordx4 v229, s[16:19], s95 offen lds
    buffer_load_dwordx4 v230, s[16:19], s95 offen offset:1024 lds
    s_mov_b32 s95, 0x600000
    buffer_load_dwordx4 v[164:167], v228, s[20:23], s95 offen offset:0
    buffer_load_dwordx4 v[168:171], v228, s[20:23], s95 offen offset:1024
    s_waitcnt vmcnt(17)
    ds_read_b64_tr_b16 v[80:81], v231 offset:8192
    ds_read_b64_tr_b16 v[82:83], v231 offset:9216
    ds_read_b64_tr_b16 v[84:85], v232 offset:8192
    ds_read_b64_tr_b16 v[86:87], v232 offset:9216
    s_waitcnt lgkmcnt(4)
    v_mfma_f32_32x32x16_bf16 v[16:31], v[88:91], v[172:175], v[16:31]
    v_mfma_f32_32x32x16_bf16 v[32:47], v[88:91], v[176:179], v[32:47]
    v_mfma_f32_32x32x16_bf16 v[48:63], v[92:95], v[172:175], v[48:63]
    v_mfma_f32_32x32x16_bf16 v[64:79], v[92:95], v[176:179], v[64:79]
    s_add_u32 m0, s94, 6144
    s_mov_b32 s95, 0x120000
    buffer_load_dwordx4 v229, s[16:19], s95 offen lds
    buffer_load_dwordx4 v230, s[16:19], s95 offen offset:1024 lds
    s_mov_b32 s95, 0x680000
    buffer_load_dwordx4 v[172:175], v228, s[20:23], s95 offen offset:0
    buffer_load_dwordx4 v[176:179], v228, s[20:23], s95 offen offset:1024
    s_waitcnt vmcnt(19)
    ds_read_b64_tr_b16 v[88:89], v231 offset:10240
    ds_read_b64_tr_b16 v[90:91], v231 offset:11264
    ds_read_b64_tr_b16 v[92:93], v232 offset:10240
    ds_read_b64_tr_b16 v[94:95], v232 offset:11264
    s_waitcnt lgkmcnt(4)
    v_mfma_f32_32x32x16_bf16 v[16:31], v[80:83], v[180:183], v[16:31]
    v_mfma_f32_32x32x16_bf16 v[32:47], v[80:83], v[184:187], v[32:47]
    v_mfma_f32_32x32x16_bf16 v[48:63], v[84:87], v[180:183], v[48:63]
    v_mfma_f32_32x32x16_bf16 v[64:79], v[84:87], v[184:187], v[64:79]
    s_add_u32 m0, s94, 8192
    s_mov_b32 s95, 0x140000
    buffer_load_dwordx4 v229, s[16:19], s95 offen lds
    buffer_load_dwordx4 v230, s[16:19], s95 offen offset:1024 lds
    s_mov_b32 s95, 0x700000
    buffer_load_dwordx4 v[180:183], v228, s[20:23], s95 offen offset:0
    buffer_load_dwordx4 v[184:187], v228, s[20:23], s95 offen offset:1024
    s_waitcnt vmcnt(18)
    ds_read_b64_tr_b16 v[80:81], v231 offset:0
    ds_read_b64_tr_b16 v[82:83], v231 offset:1024
    ds_read_b64_tr_b16 v[84:85], v232 offset:0
    ds_read_b64_tr_b16 v[86:87], v232 offset:1024
    s_waitcnt lgkmcnt(4)
    v_mfma_f32_32x32x16_bf16 v[16:31], v[88:91], v[188:191], v[16:31]
    v_mfma_f32_32x32x16_bf16 v[32:47], v[88:91], v[192:195], v[32:47]
    v_mfma_f32_32x32x16_bf16 v[48:63], v[92:95], v[188:191], v[48:63]
    v_mfma_f32_32x32x16_bf16 v[64:79], v[92:95], v[192:195], v[64:79]
    s_add_u32 m0, s94, 10240
    s_mov_b32 s95, 0x0
    buffer_load_dwordx4 v229, s[12:15], s95 offen lds
    buffer_load_dwordx4 v230, s[12:15], s95 offen offset:1024 lds
    s_waitcnt vmcnt(16)
    ds_read_b64_tr_b16 v[88:89], v231 offset:2048
    ds_read_b64_tr_b16 v[90:91], v231 offset:3072
    ds_read_b64_tr_b16 v[92:93], v232 offset:2048
    ds_read_b64_tr_b16 v[94:95], v232 offset:3072
    s_waitcnt lgkmcnt(4)
    v_mfma_f32_32x32x16_bf16 v[16:31], v[80:83], v[148:151], v[16:31]
    v_mfma_f32_32x32x16_bf16 v[32:47], v[80:83], v[152:155], v[32:47]
    v_mfma_f32_32x32x16_bf16 v[48:63], v[84:87], v[148:151], v[48:63]
    v_mfma_f32_32x32x16_bf16 v[64:79], v[84:87], v[152:155], v[64:79]
    s_add_u32 m0, s94, 0
    s_mov_b32 s95, 0x20000
    buffer_load_dwordx4 v229, s[12:15], s95 offen lds
    buffer_load_dwordx4 v230, s[12:15], s95 offen offset:1024 lds
    s_mov_b32 s28, s90
    s_mov_b32 s29, s91
    s_mov_b32 s30, 0x400
    s_mov_b32 s31, 0x00020000
    v_lshrrev_b32 v11, 3, v0
    v_and_b32 v12, 7, v0
    s_lshl_b32 s3, s92, 6
    v_add_u32 v10, s3, v11
    v_lshlrev_b32 v10, 10, v10
    s_lshl_b32 s3, s93, 7
    v_lshl_add_u32 v13, v12, 4, s3
    v_add_u32 v10, v10, v13
    buffer_load_dwordx4 v[96:99], v10, s[8:11], 0 offen
    buffer_load_dwordx4 v[100:103], v13, s[28:31], 0 offen
    s_waitcnt vmcnt(16)
    ds_read_b64_tr_b16 v[80:81], v231 offset:4096
    ds_read_b64_tr_b16 v[82:83], v231 offset:5120
    ds_read_b64_tr_b16 v[84:85], v232 offset:4096
    ds_read_b64_tr_b16 v[86:87], v232 offset:5120
    s_waitcnt lgkmcnt(4)
    v_mfma_f32_32x32x16_bf16 v[16:31], v[88:91], v[156:159], v[16:31]
    v_mfma_f32_32x32x16_bf16 v[32:47], v[88:91], v[160:163], v[32:47]
    v_mfma_f32_32x32x16_bf16 v[48:63], v[92:95], v[156:159], v[48:63]
    v_mfma_f32_32x32x16_bf16 v[64:79], v[92:95], v[160:163], v[64:79]
    s_add_u32 m0, s94, 2048
    s_mov_b32 s95, 0x40000
    buffer_load_dwordx4 v229, s[12:15], s95 offen lds
    buffer_load_dwordx4 v230, s[12:15], s95 offen offset:1024 lds
    buffer_load_dword v6, v233, s[24:27], 0 offen sc1
    s_waitcnt vmcnt(15)
    ds_read_b64_tr_b16 v[88:89], v231 offset:6144
    ds_read_b64_tr_b16 v[90:91], v231 offset:7168
    ds_read_b64_tr_b16 v[92:93], v232 offset:6144
    ds_read_b64_tr_b16 v[94:95], v232 offset:7168
    s_waitcnt lgkmcnt(4)
    v_mfma_f32_32x32x16_bf16 v[16:31], v[80:83], v[164:167], v[16:31]
    v_mfma_f32_32x32x16_bf16 v[32:47], v[80:83], v[168:171], v[32:47]
    v_mfma_f32_32x32x16_bf16 v[48:63], v[84:87], v[164:167], v[48:63]
    v_mfma_f32_32x32x16_bf16 v[64:79], v[84:87], v[168:171], v[64:79]
    s_add_u32 m0, s94, 4096
    s_mov_b32 s95, 0x60000
    buffer_load_dwordx4 v229, s[12:15], s95 offen lds
    buffer_load_dwordx4 v230, s[12:15], s95 offen offset:1024 lds
    s_waitcnt vmcnt(13)
    ds_read_b64_tr_b16 v[80:81], v231 offset:8192
    ds_read_b64_tr_b16 v[82:83], v231 offset:9216
    ds_read_b64_tr_b16 v[84:85], v232 offset:8192
    ds_read_b64_tr_b16 v[86:87], v232 offset:9216
    s_waitcnt lgkmcnt(4)
    v_mfma_f32_32x32x16_bf16 v[16:31], v[88:91], v[172:175], v[16:31]
    v_mfma_f32_32x32x16_bf16 v[32:47], v[88:91], v[176:179], v[32:47]
    v_mfma_f32_32x32x16_bf16 v[48:63], v[92:95], v[172:175], v[48:63]
    v_mfma_f32_32x32x16_bf16 v[64:79], v[92:95], v[176:179], v[64:79]
    s_waitcnt vmcnt(9)
    ds_read_b64_tr_b16 v[88:89], v231 offset:10240
    ds_read_b64_tr_b16 v[90:91], v231 offset:11264
    ds_read_b64_tr_b16 v[92:93], v232 offset:10240
    ds_read_b64_tr_b16 v[94:95], v232 offset:11264
    s_waitcnt lgkmcnt(4)
    v_mfma_f32_32x32x16_bf16 v[16:31], v[80:83], v[180:183], v[16:31]
    v_mfma_f32_32x32x16_bf16 v[32:47], v[80:83], v[184:187], v[32:47]
    v_mfma_f32_32x32x16_bf16 v[48:63], v[84:87], v[180:183], v[48:63]
    v_mfma_f32_32x32x16_bf16 v[64:79], v[84:87], v[184:187], v[64:79]
    s_waitcnt vmcnt(2)
    v_cmp_eq_u32 vcc, s36, v6
    s_cmp_eq_u32 s7, 0
    s_cbranch_scc0 K1_OOK
    s_andn2_b32 s3, 0xffff, vcc_hi
    s_cbranch_scc1 K1_OPOLL
K1_OOK:
    s_barrier
    s_mov_b32 s95, 0x0
    buffer_load_dwordx4 v[188:191], v228, s[20:23], s95 offen offset:0
    buffer_load_dwordx4 v[192:195], v228, s[20:23], s95 offen offset:1024
    s_mov_b32 s95, 0x80000
    buffer_load_dwordx4 v[148:151], v228, s[20:23], s95 offen offset:0
    buffer_load_dwordx4 v[152:155], v228, s[20:23], s95 offen offset:1024
    s_mov_b32 s95, 0x100000
    buffer_load_dwordx4 v[156:159], v228, s[20:23], s95 offen offset:0
    buffer_load_dwordx4 v[160:163], v228, s[20:23], s95 offen offset:1024
    s_mov_b32 s95, 0x180000
    buffer_load_dwordx4 v[164:167], v228, s[20:23], s95 offen offset:0
    buffer_load_dwordx4 v[168:171], v228, s[20:23], s95 offen offset:1024
    s_waitcnt vmcnt(6)
    ds_read_b64_tr_b16 v[80:81], v231 offset:0
    ds_read_b64_tr_b16 v[82:83], v231 offset:1024
    ds_read_b64_tr_b16 v[84:85], v232 offset:0
    ds_read_b64_tr_b16 v[86:87], v232 offset:1024
    s_waitcnt lgkmcnt(4)
    v_mfma_f32_32x32x16_bf16 v[16:31], v[88:91], v[188:191], v[16:31]
    v_mfma_f32_32x32x16_bf16 v[32:47], v[88:91], v[192:195], v[32:47]
    v_mfma_f32_32x32x16_bf16 v[48:63], v[92:95], v[188:191], v[48:63]
    v_mfma_f32_32x32x16_bf16 v[64:79], v[92:95], v[192:195], v[64:79]
    s_waitcnt vmcnt(4)
    ds_read_b64_tr_b16 v[88:89], v231 offset:2048
    ds_read_b64_tr_b16 v[90:91], v231 offset:3072
    ds_read_b64_tr_b16 v[92:93], v232 offset:2048
    ds_read_b64_tr_b16 v[94:95], v232 offset:3072
    s_waitcnt lgkmcnt(4)
    v_mfma_f32_32x32x16_bf16 v[16:31], v[80:83], v[148:151], v[16:31]
    v_mfma_f32_32x32x16_bf16 v[32:47], v[80:83], v[152:155], v[32:47]
    v_mfma_f32_32x32x16_bf16 v[48:63], v[84:87], v[148:151], v[48:63]
    v_mfma_f32_32x32x16_bf16 v[64:79], v[84:87], v[152:155], v[64:79]
    s_waitcnt vmcnt(2)
    ds_read_b64_tr_b16 v[80:81], v231 offset:4096
    ds_read_b64_tr_b16 v[82:83], v231 offset:5120
    ds_read_b64_tr_b16 v[84:85], v232 offset:4096
    ds_read_b64_tr_b16 v[86:87], v232 offset:5120
    s_waitcnt lgkmcnt(4)
    v_mfma_f32_32x32x16_bf16 v[16:31], v[88:91], v[156:159], v[16:31]
    v_mfma_f32_32x32x16_bf16 v[32:47], v[88:91], v[160:163], v[32:47]
    v_mfma_f32_32x32x16_bf16 v[48:63], v[92:95], v[156:159], v[48:63]
    v_mfma_f32_32x32x16_bf16 v[64:79], v[92:95], v[160:163], v[64:79]
    s_waitcnt vmcnt(0) lgkmcnt(0)
    v_mfma_f32_32x32x16_bf16 v[16:31], v[80:83], v[164:167], v[16:31]
    v_mfma_f32_32x32x16_bf16 v[32:47], v[80:83], v[168:171], v[32:47]
    v_mfma_f32_32x32x16_bf16 v[48:63], v[84:87], v[164:167], v[48:63]
    v_mfma_f32_32x32x16_bf16 v[64:79], v[84:87], v[168:171], v[64:79]
    s_mov_b32 s24, s86
    s_mov_b32 s25, s87
    s_mov_b32 s26, 0x200000
    s_mov_b32 s27, 0x00020000
    v_and_b32 v13, 31, v1
    v_mul_u32_u24 v13, 272, v13
    v_lshrrev_b32 v14, 5, v1
    v_lshl_add_u32 v13, v14, 4, v13
    s_mul_i32 s3, s7, 17408
    v_add_u32 v13, s3, v13
    v_mul_u32_u24 v14, 272, v11
    v_lshl_add_u32 v14, v12, 5, v14
    v_add_u32 v15, 69632, v14
    s_barrier
    ds_write_b128 v13, v[16:19] offset:0
    ds_write_b128 v13, v[20:23] offset:32
    ds_write_b128 v13, v[24:27] offset:64
    ds_write_b128 v13, v[28:31] offset:96
    ds_write_b128 v13, v[32:35] offset:8704
    ds_write_b128 v13, v[36:39] offset:8736
    ds_write_b128 v13, v[40:43] offset:8768
    ds_write_b128 v13, v[44:47] offset:8800
    ds_write_b128 v13, v[48:51] offset:128
    ds_write_b128 v13, v[52:55] offset:160
    ds_write_b128 v13, v[56:59] offset:192
    ds_write_b128 v13, v[60:63] offset:224
    ds_write_b128 v13, v[64:67] offset:8832
    ds_write_b128 v13, v[68:71] offset:8864
    ds_write_b128 v13, v[72:75] offset:8896
    ds_write_b128 v13, v[76:79] offset:8928
    s_waitcnt vmcnt(0)
    v_lshlrev_b32 v104, 16, v100
    v_and_b32 v105, 0xffff0000, v100
    v_lshlrev_b32 v112, 16, v96
    v_and_b32 v113, 0xffff0000, v96
    v_lshlrev_b32 v106, 16, v101
    v_and_b32 v107, 0xffff0000, v101
    v_lshlrev_b32 v114, 16, v97
    v_and_b32 v115, 0xffff0000, v97
    v_lshlrev_b32 v108, 16, v102
    v_and_b32 v109, 0xffff0000, v102
    v_lshlrev_b32 v116, 16, v98
    v_and_b32 v117, 0xffff0000, v98
    v_lshlrev_b32 v110, 16, v103
    v_and_b32 v111, 0xffff0000, v103
    v_lshlrev_b32 v118, 16, v99
    v_and_b32 v119, 0xffff0000, v99
    v_pk_add_f32 v[104:105], v[104:105], v[112:113]
    v_pk_add_f32 v[106:107], v[106:107], v[114:115]
    v_pk_add_f32 v[108:109], v[108:109], v[116:117]
    v_pk_add_f32 v[110:111], v[110:111], v[118:119]
    s_waitcnt lgkmcnt(0)
    s_barrier
    ds_read_b128 v[128:131], v14 offset:0
    ds_read_b128 v[132:135], v14 offset:16
    ds_read_b128 v[136:139], v14 offset:17408
    ds_read_b128 v[140:143], v14 offset:17424
    ds_read_b128 v[144:147], v14 offset:34816
    ds_read_b128 v[148:151], v14 offset:34832
    ds_read_b128 v[152:155], v14 offset:52224
    ds_read_b128 v[156:159], v14 offset:52240
    ds_read_b128 v[160:163], v15 offset:0
    ds_read_b128 v[164:167], v15 offset:16
    ds_read_b128 v[168:171], v15 offset:17408
    ds_read_b128 v[172:175], v15 offset:17424
    ds_read_b128 v[176:179], v15 offset:34816
    ds_read_b128 v[180:183], v15 offset:34832
    ds_read_b128 v[184:187], v15 offset:52224
    ds_read_b128 v[188:191], v15 offset:52240
    s_waitcnt lgkmcnt(14)
    v_pk_add_f32 v[104:105], v[104:105], v[128:129]
    v_pk_add_f32 v[106:107], v[106:107], v[130:131]
    v_pk_add_f32 v[108:109], v[108:109], v[132:133]
    v_pk_add_f32 v[110:111], v[110:111], v[134:135]
    s_waitcnt lgkmcnt(12)
    v_pk_add_f32 v[104:105], v[104:105], v[136:137]
    v_pk_add_f32 v[106:107], v[106:107], v[138:139]
    v_pk_add_f32 v[108:109], v[108:109], v[140:141]
    v_pk_add_f32 v[110:111], v[110:111], v[142:143]
    s_waitcnt lgkmcnt(10)
    v_pk_add_f32 v[104:105], v[104:105], v[144:145]
    v_pk_add_f32 v[106:107], v[106:107], v[146:147]
    v_pk_add_f32 v[108:109], v[108:109], v[148:149]
    v_pk_add_f32 v[110:111], v[110:111], v[150:151]
    s_waitcnt lgkmcnt(8)
    v_pk_add_f32 v[104:105], v[104:105], v[152:153]
    v_pk_add_f32 v[106:107], v[106:107], v[154:155]
    v_pk_add_f32 v[108:109], v[108:109], v[156:157]
    v_pk_add_f32 v[110:111], v[110:111], v[158:159]
    s_waitcnt lgkmcnt(6)
    v_pk_add_f32 v[104:105], v[104:105], v[160:161]
    v_pk_add_f32 v[106:107], v[106:107], v[162:163]
    v_pk_add_f32 v[108:109], v[108:109], v[164:165]
    v_pk_add_f32 v[110:111], v[110:111], v[166:167]
    s_waitcnt lgkmcnt(4)
    v_pk_add_f32 v[104:105], v[104:105], v[168:169]
    v_pk_add_f32 v[106:107], v[106:107], v[170:171]
    v_pk_add_f32 v[108:109], v[108:109], v[172:173]
    v_pk_add_f32 v[110:111], v[110:111], v[174:175]
    s_waitcnt lgkmcnt(2)
    v_pk_add_f32 v[104:105], v[104:105], v[176:177]
    v_pk_add_f32 v[106:107], v[106:107], v[178:179]
    v_pk_add_f32 v[108:109], v[108:109], v[180:181]
    v_pk_add_f32 v[110:111], v[110:111], v[182:183]
    s_waitcnt lgkmcnt(0)
    v_pk_add_f32 v[104:105], v[104:105], v[184:185]
    v_pk_add_f32 v[106:107], v[106:107], v[186:187]
    v_pk_add_f32 v[108:109], v[108:109], v[188:189]
    v_pk_add_f32 v[110:111], v[110:111], v[190:191]
    v_cvt_pk_bf16_f32 v96, v104, v105
    v_cvt_pk_bf16_f32 v97, v106, v107
    v_cvt_pk_bf16_f32 v98, v108, v109
    v_cvt_pk_bf16_f32 v99, v110, v111
    buffer_store_dwordx4 v[96:99], v10, s[24:27], 0 offen
K1_END:
    s_endpgm
K1_SPOLL:
    s_mov_b32 s4, 0
K1_SP2:
    buffer_load_dword v3, v233, s[24:27], 0 offen sc1
    s_add_u32 s4, s4, 1
    s_waitcnt vmcnt(0)
    v_cmp_eq_u32 vcc, s36, v3
    s_cmp_lt_u32 s4, 0x40000
    s_cbranch_scc0 K1_SOK
    s_andn2_b32 s3, s61, vcc_lo
    s_cbranch_scc0 K1_SOK
    s_movk_i32 s3, 20
K1_SP2D:
    s_sub_u32 s3, s3, 1
    s_cbranch_scc0 K1_SP2D
    s_branch K1_SP2
    s_branch K1_SOK
K1_NPOLL:
    s_mov_b32 s4, 0
K1_NP2:
    buffer_load_dword v107, v236, s[28:31], 0 offen sc1
    s_add_u32 s4, s4, 1
    s_waitcnt vmcnt(0)
    v_readfirstlane_b32 s36, v107
    s_cmp_lt_u32 s4, 0x40000
    s_cbranch_scc0 K1_NOK
    s_or_b32 s3, s36, s7
    s_cbranch_scc0 K1_NP2
    s_branch K1_NOK
K1_OPOLL:
    s_mov_b32 s4, 0
K1_OP2:
    buffer_load_dword v3, v233, s[24:27], 0 offen sc1
    s_add_u32 s4, s4, 1
    s_waitcnt vmcnt(0)
    v_cmp_eq_u32 vcc, s36, v3
    s_cmp_lt_u32 s4, 0x40000
    s_cbranch_scc0 K1_OOK
    s_andn2_b32 s3, 65535, vcc_hi
    s_cbranch_scc0 K1_OOK
    s_movk_i32 s3, 20
K1_OP2D:
    s_sub_u32 s3, s3, 1
    s_cbranch_scc0 K1_OP2D
    s_branch K1_OP2
    s_branch K1_OOK
K1_IDLE:
    s_cmp_eq_u32 s5, 0
    s_cbranch_scc0 K1_IDLE2
    s_memrealtime s[46:47]
    s_waitcnt lgkmcnt(0)
    s_or_b32 s36, s46, 1
    v_mov_b32 v107, s36
    buffer_store_dword v107, v236, s[28:31], 0 offen sc1
K1_IDLE2:
    s_lshr_b32 s92, s2, 6
    s_and_b32 s3, s2, 7
    s_lshl_b32 s3, s3, 2
    s_add_u32 s92, s92, s3
    s_bfe_u32 s93, s2, 0x30003
    s_mul_i32 s94, s7, 12288
    s_add_u32 s94, s94, 57344
    v_lshrrev_b32 v3, 3, v1
    v_lshl_add_u32 v3, v2, 4, v3
    v_lshlrev_b32 v3, 10, v3
    v_bfe_u32 v4, v1, 4, 1
    v_lshlrev_b32 v4, 2, v4
    v_and_b32 v5, 7, v1
    v_xor_b32 v4, v4, v5
    v_lshlrev_b32 v4, 4, v4
    s_lshl_b32 s3, s93, 7
    v_add3_u32 v229, v3, v4, s3
    v_add_u32 v230, 7168, v229
    s_mov_b32 s12, s84
    s_mov_b32 s13, s85
    s_mov_b32 s14, 0x80000
    s_mov_b32 s15, 0x00020000
    s_mov_b32 s16, s88
    s_mov_b32 s17, s89
    s_mov_b32 s18, 0x158000
    s_mov_b32 s19, 0x00020000
    v_lshlrev_b32 v3, 4, v1
    v_lshlrev_b32 v4, 16, v2
    s_lshl_b32 s3, s92, 11
    v_add3_u32 v228, v3, v4, s3
    v_lshrrev_b32 v3, 5, v1
    v_bfe_u32 v4, v1, 2, 2
    v_lshl_add_u32 v3, v3, 2, v4
    v_lshlrev_b32 v3, 7, v3
    v_bfe_u32 v4, v1, 4, 1
    v_bfe_u32 v5, v1, 1, 1
    v_lshl_add_u32 v4, v4, 1, v5
    v_bfe_u32 v5, v1, 3, 1
    v_lshl_add_u32 v4, v5, 2, v4
    v_and_b32 v5, 1, v1
    v_lshlrev_b32 v5, 3, v5
    v_lshl_add_u32 v4, v4, 4, v5
    v_add3_u32 v231, v3, v4, s94
    v_xor_b32 v232, 64, v231
    s_and_b32 s3, s2, -8
    s_add_u32 s3, s3, s7
    s_cmp_lt_u32 s3, 172
    s_cselect_b32 s76, s88, s84
    s_cselect_b32 s77, s89, s85
    s_mov_b32 s78, 0x80000
    s_cselect_b32 s78, 0x158000, s78
    s_cselect_b32 s4, 0, 172
    s_mov_b32 s79, 0x00020000
    s_sub_u32 s3, s3, s4
    s_lshl_b32 s3, s3, 13
    v_lshl_add_u32 v237, v1, 7, s3
    buffer_load_dword v238, v237, s[76:79], 0 offen
    s_add_u32 m0, s94, 0
    s_mov_b32 s95, 0x0
    buffer_load_dwordx4 v229, s[16:19], s95 offen lds
    buffer_load_dwordx4 v230, s[16:19], s95 offen offset:1024 lds
    s_add_u32 m0, s94, 2048
    s_mov_b32 s95, 0x20000
    buffer_load_dwordx4 v229, s[16:19], s95 offen lds
    buffer_load_dwordx4 v230, s[16:19], s95 offen offset:1024 lds
    s_add_u32 m0, s94, 4096
    s_mov_b32 s95, 0x40000
    buffer_load_dwordx4 v229, s[16:19], s95 offen lds
    buffer_load_dwordx4 v230, s[16:19], s95 offen offset:1024 lds
    s_add_u32 m0, s94, 6144
    s_mov_b32 s95, 0x60000
    buffer_load_dwordx4 v229, s[16:19], s95 offen lds
    buffer_load_dwordx4 v230, s[16:19], s95 offen offset:1024 lds
    s_add_u32 m0, s94, 8192
    s_mov_b32 s95, 0x80000
    buffer_load_dwordx4 v229, s[16:19], s95 offen lds
    buffer_load_dwordx4 v230, s[16:19], s95 offen offset:1024 lds
    s_add_u32 m0, s94, 10240
    s_mov_b32 s95, 0xa0000
    buffer_load_dwordx4 v229, s[16:19], s95 offen lds
    buffer_load_dwordx4 v230, s[16:19], s95 offen offset:1024 lds
    s_mov_b32 s4, 0
K1_NP3:
    buffer_load_dword v107, v236, s[28:31], 0 offen sc1
    s_add_u32 s4, s4, 1
    s_waitcnt vmcnt(0)
    v_readfirstlane_b32 s36, v107
    s_cmp_lt_u32 s4, 0x40000
    s_cbranch_scc0 K1_HPOLL
    s_or_b32 s3, s36, s7
    s_cbranch_scc0 K1_NP3
    s_branch K1_HPOLL
.section .rodata,"a"
.p2align 6
.amdhsa_kernel parallel_sum__linear_kernel_hedgehog__mixer_channel_mlp__prompt_kernel
  .amdhsa_next_free_vgpr 240
  .amdhsa_next_free_sgpr 96
  .amdhsa_accum_offset 240
  .amdhsa_group_segment_fixed_size 0
  .amdhsa_kernarg_size 96
  .amdhsa_user_sgpr_count 2
  .amdhsa_user_sgpr_kernarg_segment_ptr 1
  .amdhsa_system_sgpr_workgroup_id_x 1
.end_amdhsa_kernel
```
